```python
import torch

def _softmax(x, axis=-1):
    return torch.softmax(x, dim=axis)
def _gelu(x):
    return torch.nn.functional.gelu(x, approximate="tanh")
def _silu(x):
    return torch.nn.functional.silu(x)
def _sigmoid(x):
    return torch.sigmoid(x)
def _layernorm(x, axis=-1, eps=1e-5):
    m = x.mean(dim=axis, keepdim=True)
    v = x.var(dim=axis, keepdim=True, unbiased=False)
    return (x - m) / torch.sqrt(v + eps)
def _scatter_add(tgt, idx, src, axis=0):
    return tgt.clone().index_add_(axis, idx, src)
def _segment_sum(src, seg, n):
    out = torch.zeros((n,) + src.shape[1:], dtype=src.dtype)
    return out.index_add_(0, seg, src)
def _pad(x, pw):
    flat = tuple(v for pair in reversed(pw) for v in pair)
    return torch.nn.functional.pad(x, flat)

kernel_name = 'gated_mix__ssm_conv_s4d__dense_activation_squared_relu__prompt'

def setup_inputs():

    _w = (lambda a: (lambda t: t.to(torch.bfloat16) if t.is_floating_point() else t)(torch.as_tensor(a)))
    def _A_setup():
        Bsz, L, D, N = 1, 2048, 512, 128
        return {
            "u": _w((lambda *s: torch.randn(*s, dtype=torch.bfloat16) * 0.05)(Bsz, L, D)),
            "log_A_real": _w((lambda *s: torch.randn(*s, dtype=torch.bfloat16) * 6.4)(D, N) * 0.5),
            "A_imag": _w((lambda *s: torch.randn(*s, dtype=torch.bfloat16) * 0.1)(D, N) * 3.14),
            "C_real": _w((lambda *s: torch.randn(*s, dtype=torch.bfloat16) * 0.4)(D, N) / N ** 0.5),
            "C_imag": _w((lambda *s: torch.randn(*s, dtype=torch.bfloat16) * 0.4)(D, N) / N ** 0.5),
            "log_dt": _w((lambda *s: torch.randn(*s, dtype=torch.bfloat16) * 0.1)(D) * 0.5 - 4.0),
            "D_skip": _w((lambda *s: torch.randn(*s, dtype=torch.bfloat16) * 0.1)(D)),
        }
    _A_in = _A_setup()

    def _B_setup():
        B, S, D, F = 1, 2048, 512, 1792
        return {
            "x": _w((lambda *s: torch.randn(*s, dtype=torch.bfloat16) * 0.05)(B, S, D)),
            "w1": _w((lambda *s: torch.randn(*s, dtype=torch.bfloat16) * 0.05)(D, F)),
            "b1": _w((lambda *s: torch.randn(*s, dtype=torch.bfloat16) * 0.05)(F)),
            "w2": _w((lambda *s: torch.randn(*s, dtype=torch.bfloat16) * 0.05)(F, D)),
            "b2": _w((lambda *s: torch.randn(*s, dtype=torch.bfloat16) * 0.05)(D)),
        }
    _B_in = _B_setup()

    return {
        "A_u": _A_in["u"],
        "A_log_A_real": _A_in["log_A_real"],
        "A_A_imag": _A_in["A_imag"],
        "A_C_real": _A_in["C_real"],
        "A_C_imag": _A_in["C_imag"],
        "A_log_dt": _A_in["log_dt"],
        "A_D_skip": _A_in["D_skip"],
        "B_x": _B_in["x"],
        "B_w1": _B_in["w1"],
        "B_b1": _B_in["b1"],
        "B_w2": _B_in["w2"],
        "B_b2": _B_in["b2"],
        "gate_w": _w((lambda *s: torch.randn(*s, dtype=torch.bfloat16) * 0.05)(512) * 16.0),
    }

def reference(A_u, A_log_A_real, A_A_imag, A_C_real, A_C_imag, A_log_dt, A_D_skip, B_x, B_w1, B_b1, B_w2, B_b2, gate_w):
    def _A_ref(u, log_A_real, A_imag, C_real, C_imag, log_dt, D_skip):
        L = u.shape[1]
        dt = torch.exp(log_dt)
        A = -torch.exp(log_A_real) + 1j * A_imag
        C = (C_real + 1j * C_imag) * dt[:, None]
        pos = (lambda x, dt: x.to(dt))(torch.arange(L), log_dt.dtype)
        P = torch.exp((A * dt[:, None])[:, :, None] * pos[None, None, :])
        K = 2.0 * torch.einsum("dn,dnl->dl", C, P).real
        L2 = 2 * L
        u_t = (lambda x, *d: x.permute(*d))(u, 0, 2, 1)
        Kf = (lambda x, *a, **k: torch.fft.rfft(x.float(), *a, **k))(K, L2)
        Uf = (lambda x, *a, **k: torch.fft.rfft(x.float(), *a, **k))(u_t, L2)
        y = (lambda x, *a, **k: torch.fft.irfft(x, *a, **k).to(torch.bfloat16))(Uf * Kf[None, :, :], L2)[:, :, :L]
        y = (lambda x, *d: x.permute(*d))(y, 0, 2, 1)
        return y + u * D_skip[None, None, :]

    def _B_ref(x, w1, b1, w2, b2):
        h = torch.einsum("bsd,df->bsf", x, w1) + b1
        zero = torch.zeros_like(h)
        r = torch.where(h > zero, h, zero)
        h = r * r
        out = torch.einsum("bsf,fd->bsd", h, w2) + b2
        return out

    x = A_u
    g = _sigmoid((x * gate_w).sum(-1, keepdims=True))
    a = _A_ref(x, A_log_A_real, A_A_imag, A_C_real, A_C_imag, A_log_dt, A_D_skip)
    b = _B_ref(x, B_w1, B_b1, B_w2, B_b2)
    return g * a + (1 - g) * b
```

```asm
; @launch grid=(512,1,1) block=(256,1,1) lds=81920
.amdgcn_target "amdgcn-amd-amdhsa--gfx950"
.text
.globl gated_mix__ssm_conv_s4d__dense_activation_squared_relu__prompt_kernel
.p2align 8
.type gated_mix__ssm_conv_s4d__dense_activation_squared_relu__prompt_kernel,@function
gated_mix__ssm_conv_s4d__dense_activation_squared_relu__prompt_kernel:
    s_cmp_ge_u32 s2, 512
    s_cbranch_scc1 k_end
    s_load_dwordx16 s[36:51], s[0:1], 0
    s_load_dwordx16 s[52:67], s[0:1], 64
    s_getpc_b64 s[32:33]
k_pc:
    s_lshl_b32 s3, s2, 8
    s_and_b32 s3, s3, 0x7800
    v_lshl_add_u32 v2, v0, 7, s3
    v_min_u32 v2, k_end-k_pc, v2
    v_cmp_gt_u32 vcc, 16, v0
    s_and_saveexec_b64 s[4:5], vcc
    s_cbranch_execz k_npt
    global_load_dword v255, v2, s[32:33]
k_npt:
    s_mov_b64 exec, -1
    s_cmp_lt_u32 s2, 256
    s_cbranch_scc1 k_g
    s_setprio 3
    s_sub_u32 s80, s2, 256
    s_and_b32 s81, s80, 7
    s_lshl_b32 s81, s81, 2
    s_lshr_b32 s82, s80, 3
    s_and_b32 s72, s82, 3
    s_add_u32 s81, s81, s72
    s_lshr_b32 s82, s82, 2
    s_lshl_b32 s83, s81, 3
    s_add_u32 s83, s83, s82
    v_and_b32 v1, 63, v0
    v_lshrrev_b32 v2, 6, v0
    s_nop 0
    v_readfirstlane_b32 s70, v2
    s_nop 3
    s_waitcnt lgkmcnt(0)
    s_mov_b32 s12, s38
    s_mov_b32 s13, s39
    s_mov_b32 s14, 131072
    s_mov_b32 s15, 0x00020000
    s_mov_b32 s16, s40
    s_mov_b32 s17, s41
    s_mov_b32 s18, 131072
    s_mov_b32 s19, 0x00020000
    s_mov_b32 s20, s42
    s_mov_b32 s21, s43
    s_mov_b32 s22, 131072
    s_mov_b32 s23, 0x00020000
    s_mov_b32 s24, s44
    s_mov_b32 s25, s45
    s_mov_b32 s26, 131072
    s_mov_b32 s27, 0x00020000
    s_mov_b32 s28, s46
    s_mov_b32 s29, s47
    s_mov_b32 s30, 1024
    s_mov_b32 s31, 0x00020000
    s_mov_b32 s32, s48
    s_mov_b32 s33, s49
    s_mov_b32 s34, 1024
    s_mov_b32 s35, 0x00020000
    v_lshlrev_b32 v6, 1, v0
    s_lshl_b32 s72, s80, 9
    buffer_load_ushort v40, v6, s[12:15], s72 offen
    buffer_load_ushort v41, v6, s[16:19], s72 offen
    buffer_load_ushort v42, v6, s[20:23], s72 offen
    buffer_load_ushort v43, v6, s[24:27], s72 offen
    v_lshrrev_b32 v7, 7, v0
    v_lshlrev_b32 v7, 1, v7
    s_lshl_b32 s72, s80, 2
    buffer_load_ushort v44, v7, s[28:31], s72 offen
    buffer_load_ushort v45, v7, s[32:35], s72 offen
    s_setprio 1
    s_branch k_ssm
k_g:
    s_and_b32 s80, s2, 7
    s_lshr_b32 s81, s2, 3
    s_lshl_b32 s82, s80, 2
    s_lshr_b32 s74, s81, 3
    s_add_u32 s82, s82, s74
    s_and_b32 s83, s81, 7
    s_mov_b32 s76, s81
    s_and_b32 s74, s81, 3
    s_lshr_b32 s81, s81, 2
    s_and_b32 s71, s80, 1
    s_mul_i32 s71, s71, 7
    s_add_u32 s81, s81, s71
    s_lshr_b32 s80, s80, 1
    s_lshl_b32 s71, s74, 1
    s_add_u32 s71, s71, s81
    s_mul_i32 s72, s80, 1
    s_add_u32 s71, s71, s72
    s_lshl_b32 s80, s80, 2
    s_add_u32 s80, s80, s74
    v_and_b32 v1, 63, v0
    v_mov_b32 v10, 0
    v_lshrrev_b32 v11, 6, v0
    s_nop 0
    v_readfirstlane_b32 s70, v11
    s_nop 3
    s_setprio 2
    v_lshrrev_b32 v11, 3, v1
    v_lshrrev_b32 v12, 4, v1
    v_and_b32 v13, 7, v1
    s_lshl_b32 s74, s70, 15
    v_lshl_add_u32 v11, v11, 10, s74
    v_add_u32 v14, 0, v12
    v_xor_b32 v14, v13, v14
    v_lshl_add_u32 v80, v14, 4, v11
    v_add_u32 v14, 4, v12
    v_xor_b32 v14, v13, v14
    v_lshl_add_u32 v81, v14, 4, v11
    v_add_u32 v81, 7168, v81
    v_add_u32 v14, 0, v12
    v_xor_b32 v14, v13, v14
    v_lshl_add_u32 v82, v14, 4, v11
    v_add_u32 v82, 14336, v82
    v_add_u32 v14, 4, v12
    v_xor_b32 v14, v13, v14
    v_lshl_add_u32 v83, v14, 4, v11
    v_add_u32 v83, 21504, v83
    s_mul_i32 s74, s70, 28672
    v_mul_u32_u24 v11, 3584, v12
    v_add_u32 v11, s74, v11
    v_and_b32 v13, 15, v1
    v_lshlrev_b32 v14, 2, v12
    v_xor_b32 v13, v13, v14
    v_lshl_add_u32 v84, v13, 4, v11
    v_add_u32 v85, 13312, v84
    s_lshl_b32 s72, s80, 17
    s_lshl_b32 s73, s81, 8
    s_lshl_b32 s75, s70, 11
    s_waitcnt lgkmcnt(0)
    s_mov_b32 s4, s36
    s_mov_b32 s5, s37
    s_mov_b32 s6, 2097152
    s_mov_b32 s7, 0x00020000
    s_mov_b32 s8, s52
    s_mov_b32 s9, s53
    s_mov_b32 s10, 1835008
    s_mov_b32 s11, 0x00020000
    s_mov_b32 s12, s54
    s_mov_b32 s13, s55
    s_mov_b32 s14, 3584
    s_mov_b32 s15, 0x00020000
    s_add_u32 s16, s66, 8388608
    s_addc_u32 s17, s67, 0
    s_mov_b32 s18, 7340032
    s_mov_b32 s19, 0x00020000
    s_mov_b32 s20, s56
    s_mov_b32 s21, s57
    s_mov_b32 s22, 1835008
    s_mov_b32 s23, 0x00020000
    s_mov_b32 s24, s64
    s_mov_b32 s25, s65
    s_mov_b32 s26, 256
    s_mov_b32 s27, 0x00020000
    s_add_u32 s28, s66, 6291456
    s_addc_u32 s29, s67, 0
    s_mov_b32 s30, 131072
    s_mov_b32 s31, 0x00020000
    s_or_b32 s74, s2, s70
    s_cmp_lg_u32 s74, 0
    s_cbranch_scc1 ntok_1
    s_memrealtime s[34:35]
    s_waitcnt lgkmcnt(0)
    s_or_b32 s34, s34, 1
    v_mov_b32 v8, s34
    v_mov_b32 v9, s35
    s_mov_b64 exec, 1
    buffer_store_dwordx2 v[8:9], v10, s[24:27], 0 offen sc1
    s_mov_b64 exec, -1
ntok_1:
    s_cmp_ge_u32 s76, 28
    s_cbranch_scc1 g1skip_2
    s_and_b32 s74, s70, 1
    s_lshl_b32 s74, s74, 7
    s_add_u32 s74, s74, s73
    v_lshrrev_b32 v11, 5, v1
    v_lshlrev_b32 v11, 3, v11
    s_lshl_b32 s100, s75, 1
    buffer_load_dwordx2 v[160:161], v11, s[12:15], s74 offen offset:0
    buffer_load_dwordx2 v[162:163], v11, s[12:15], s74 offen offset:16
    buffer_load_dwordx2 v[164:165], v11, s[12:15], s74 offen offset:32
    buffer_load_dwordx2 v[166:167], v11, s[12:15], s74 offen offset:48
    buffer_load_dwordx2 v[168:169], v11, s[12:15], s74 offen offset:64
    buffer_load_dwordx2 v[170:171], v11, s[12:15], s74 offen offset:80
    buffer_load_dwordx2 v[172:173], v11, s[12:15], s74 offen offset:96
    buffer_load_dwordx2 v[174:175], v11, s[12:15], s74 offen offset:112
    s_add_u32 s3, s71, 0
    s_and_b32 s3, s3, 7
    s_lshl_b32 s3, s3, 7
    s_add_u32 s3, s3, s72
    s_add_u32 m0, s100, 0
    s_nop 0
    buffer_load_dwordx4 v80, s[4:7], s3 offen offset:0 lds
    s_add_u32 m0, s100, 0
    s_nop 0
    buffer_load_dwordx4 v81, s[4:7], s3 offen offset:1024 lds
    s_add_u32 m0, s100, 0
    s_nop 0
    buffer_load_dwordx4 v82, s[4:7], s3 offen offset:2048 lds
    s_add_u32 m0, s100, 0
    s_nop 0
    buffer_load_dwordx4 v83, s[4:7], s3 offen offset:3072 lds
    s_add_u32 s33, s71, 0
    s_and_b32 s33, s33, 7
    s_mul_i32 s33, s33, 229376
    s_add_u32 s33, s33, s73
    s_add_u32 m0, s75, 49152
    s_nop 0
    buffer_load_dwordx4 v84, s[8:11], s33 offen offset:0 lds
    s_add_u32 m0, s75, 49152
    s_nop 0
    buffer_load_dwordx4 v85, s[8:11], s33 offen offset:1024 lds
    s_add_u32 s33, s33, 114688
    s_add_u32 m0, s75, 57344
    s_nop 0
    buffer_load_dwordx4 v84, s[8:11], s33 offen offset:0 lds
    s_add_u32 m0, s75, 57344
    s_nop 0
    buffer_load_dwordx4 v85, s[8:11], s33 offen offset:1024 lds
    s_add_u32 s3, s71, 1
    s_and_b32 s3, s3, 7
    s_lshl_b32 s3, s3, 7
    s_add_u32 s3, s3, s72
    s_add_u32 m0, s100, 16384
    s_nop 0
    buffer_load_dwordx4 v80, s[4:7], s3 offen offset:0 lds
    s_add_u32 m0, s100, 16384
    s_nop 0
    buffer_load_dwordx4 v81, s[4:7], s3 offen offset:1024 lds
    s_add_u32 m0, s100, 16384
    s_nop 0
    buffer_load_dwordx4 v82, s[4:7], s3 offen offset:2048 lds
    s_add_u32 m0, s100, 16384
    s_nop 0
    buffer_load_dwordx4 v83, s[4:7], s3 offen offset:3072 lds
    s_add_u32 s33, s71, 1
    s_and_b32 s33, s33, 7
    s_mul_i32 s33, s33, 229376
    s_add_u32 s33, s33, s73
    s_add_u32 m0, s75, 65536
    s_nop 0
    buffer_load_dwordx4 v84, s[8:11], s33 offen offset:0 lds
    s_add_u32 m0, s75, 65536
    s_nop 0
    buffer_load_dwordx4 v85, s[8:11], s33 offen offset:1024 lds
    v_bfe_u32 v11, v1, 2, 2
    v_lshrrev_b32 v12, 5, v1
    v_lshl_add_u32 v13, v12, 3, v11
    v_lshlrev_b32 v13, 8, v13
    v_and_b32 v14, 1, v1
    v_lshl_add_u32 v13, v14, 3, v13
    v_bfe_u32 v14, v1, 4, 1
    v_bfe_u32 v15, v1, 1, 1
    v_lshl_add_u32 v14, v14, 1, v15
    s_and_b32 s74, s70, 1
    s_lshl_b32 s74, s74, 3
    v_add_u32 v14, s74, v14
    v_lshlrev_b32 v15, 2, v11
    v_xor_b32 v14, v14, v15
    v_lshl_add_u32 v86, v14, 4, v13
    v_add_u32 v86, 49152, v86
    v_xor_b32 v87, 64, v86
    s_lshr_b32 s74, s70, 1
    s_lshl_b32 s74, s74, 13
    v_and_b32 v11, 31, v1
    v_lshl_add_u32 v13, v11, 7, s74
    v_bfe_u32 v14, v1, 1, 3
    v_xor_b32 v14, v14, v12
    v_lshl_add_u32 v88, v14, 4, v13
    v_xor_b32 v89, 32, v88
    v_xor_b32 v90, 64, v88
    v_xor_b32 v91, 96, v88
    v_lshrrev_b32 v11, 3, v1
    v_lshlrev_b32 v11, 10, v11
    v_bfe_u32 v12, v1, 4, 1
    v_lshlrev_b32 v12, 2, v12
    v_and_b32 v13, 7, v1
    v_xor_b32 v12, v12, v13
    v_lshl_add_u32 v2, v12, 4, v11
    v_add_u32 v3, 7168, v2
    s_and_b32 s74, s70, 1
    s_mul_i32 s74, s74, 114688
    v_lshl_add_u32 v6, v1, 4, s74
    s_sub_u32 s74, 114688, s74
    v_lshl_add_u32 v7, v1, 4, s74
    s_mul_i32 s78, s82, 229376
    s_mul_i32 s74, s70, 28672
    s_add_u32 s78, s78, s74
    s_lshl_b32 s79, s83, 7
    s_mul_i32 s74, s70, 458752
    s_add_u32 s79, s79, s74
    s_mul_i32 s77, s82, 7
    s_lshr_b32 s77, s77, 3
    s_mul_i32 s74, s83, 7
    s_lshr_b32 s74, s74, 1
    s_add_u32 s77, s77, s74
    s_cmp_ge_u32 s77, 28
    s_cselect_b32 s74, 28, 0
    s_sub_u32 s77, s77, s74
    s_mov_b32 s68, s77
    v_bfe_u32 v11, v1, 2, 2
    v_lshrrev_b32 v12, 5, v1
    v_lshl_add_u32 v13, v12, 2, v11
    v_lshlrev_b32 v13, 7, v13
    v_and_b32 v14, 1, v1
    v_lshl_add_u32 v13, v14, 3, v13
    v_add_u32 v13, s75, v13
    v_bfe_u32 v14, v1, 4, 1
    v_bfe_u32 v15, v1, 1, 1
    v_lshl_add_u32 v14, v14, 1, v15
    v_bfe_u32 v15, v1, 3, 1
    s_lshr_b32 s74, s70, 1
    v_xor_b32 v15, s74, v15
    v_lshl_add_u32 v14, v15, 2, v14
    v_lshl_add_u32 v4, v14, 4, v13
    v_add_u32 v4, 0x4000, v4
    v_xor_b32 v5, 64, v4
    s_waitcnt vmcnt(14)
    v_lshlrev_b32 v16, 16, v160
    v_and_b32 v17, 0xffff0000, v160
    v_lshlrev_b32 v32, 16, v160
    v_and_b32 v33, 0xffff0000, v160
    v_lshlrev_b32 v18, 16, v161
    v_and_b32 v19, 0xffff0000, v161
    v_lshlrev_b32 v34, 16, v161
    v_and_b32 v35, 0xffff0000, v161
    v_lshlrev_b32 v20, 16, v162
    v_and_b32 v21, 0xffff0000, v162
    v_lshlrev_b32 v36, 16, v162
    v_and_b32 v37, 0xffff0000, v162
    v_lshlrev_b32 v22, 16, v163
    v_and_b32 v23, 0xffff0000, v163
    v_lshlrev_b32 v38, 16, v163
    v_and_b32 v39, 0xffff0000, v163
    v_lshlrev_b32 v24, 16, v164
    v_and_b32 v25, 0xffff0000, v164
    v_lshlrev_b32 v40, 16, v164
    v_and_b32 v41, 0xffff0000, v164
    v_lshlrev_b32 v26, 16, v165
    v_and_b32 v27, 0xffff0000, v165
    v_lshlrev_b32 v42, 16, v165
    v_and_b32 v43, 0xffff0000, v165
    v_lshlrev_b32 v28, 16, v166
    v_and_b32 v29, 0xffff0000, v166
    v_lshlrev_b32 v44, 16, v166
    v_and_b32 v45, 0xffff0000, v166
    v_lshlrev_b32 v30, 16, v167
    v_and_b32 v31, 0xffff0000, v167
    v_lshlrev_b32 v46, 16, v167
    v_and_b32 v47, 0xffff0000, v167
    v_lshlrev_b32 v48, 16, v168
    v_and_b32 v49, 0xffff0000, v168
    v_lshlrev_b32 v64, 16, v168
    v_and_b32 v65, 0xffff0000, v168
    v_lshlrev_b32 v50, 16, v169
    v_and_b32 v51, 0xffff0000, v169
    v_lshlrev_b32 v66, 16, v169
    v_and_b32 v67, 0xffff0000, v169
    v_lshlrev_b32 v52, 16, v170
    v_and_b32 v53, 0xffff0000, v170
    v_lshlrev_b32 v68, 16, v170
    v_and_b32 v69, 0xffff0000, v170
    v_lshlrev_b32 v54, 16, v171
    v_and_b32 v55, 0xffff0000, v171
    v_lshlrev_b32 v70, 16, v171
    v_and_b32 v71, 0xffff0000, v171
    v_lshlrev_b32 v56, 16, v172
    v_and_b32 v57, 0xffff0000, v172
    v_lshlrev_b32 v72, 16, v172
    v_and_b32 v73, 0xffff0000, v172
    v_lshlrev_b32 v58, 16, v173
    v_and_b32 v59, 0xffff0000, v173
    v_lshlrev_b32 v74, 16, v173
    v_and_b32 v75, 0xffff0000, v173
    v_lshlrev_b32 v60, 16, v174
    v_and_b32 v61, 0xffff0000, v174
    v_lshlrev_b32 v76, 16, v174
    v_and_b32 v77, 0xffff0000, v174
    v_lshlrev_b32 v62, 16, v175
    v_and_b32 v63, 0xffff0000, v175
    v_lshlrev_b32 v78, 16, v175
    v_and_b32 v79, 0xffff0000, v175
    s_waitcnt vmcnt(8)
    s_barrier
    ds_read_b64_tr_b16 v[96:97], v86 offset:0
    ds_read_b64_tr_b16 v[98:99], v86 offset:1024
    ds_read_b128 v[104:107], v88 offset:0
    ds_read_b64_tr_b16 v[100:101], v87 offset:0
    ds_read_b64_tr_b16 v[102:103], v87 offset:1024
    ds_read_b128 v[108:111], v88 offset:4096
    ds_read_b64_tr_b16 v[112:113], v86 offset:4096
    ds_read_b64_tr_b16 v[114:115], v86 offset:5120
    ds_read_b128 v[120:123], v89 offset:0
    ds_read_b64_tr_b16 v[116:117], v87 offset:4096
    ds_read_b64_tr_b16 v[118:119], v87 offset:5120
    ds_read_b128 v[124:127], v89 offset:4096
    s_add_u32 s33, s33, 114688
    s_add_u32 m0, s75, 73728
    s_nop 0
    buffer_load_dwordx4 v84, s[8:11], s33 offen offset:0 lds
    s_add_u32 m0, s75, 73728
    s_nop 0
    buffer_load_dwordx4 v85, s[8:11], s33 offen offset:1024 lds
    s_add_u32 s3, s71, 2
    s_and_b32 s3, s3, 7
    s_lshl_b32 s3, s3, 7
    s_add_u32 s3, s3, s72
    s_add_u32 m0, s100, 32768
    s_nop 0
    buffer_load_dwordx4 v80, s[4:7], s3 offen offset:0 lds
    s_add_u32 m0, s100, 32768
    s_nop 0
    buffer_load_dwordx4 v81, s[4:7], s3 offen offset:1024 lds
    s_add_u32 m0, s100, 32768
    s_nop 0
    buffer_load_dwordx4 v82, s[4:7], s3 offen offset:2048 lds
    s_add_u32 m0, s100, 32768
    s_nop 0
    buffer_load_dwordx4 v83, s[4:7], s3 offen offset:3072 lds
    s_waitcnt vmcnt(12) lgkmcnt(0)
    s_barrier
    v_mfma_f32_32x32x16_bf16 v[16:31], v[96:99], v[104:107], v[16:31]
    ds_read_b64_tr_b16 v[128:129], v86 offset:8192
    ds_read_b64_tr_b16 v[130:131], v86 offset:9216
    s_add_u32 s33, s71, 2
    s_and_b32 s33, s33, 7
    s_mul_i32 s33, s33, 229376
    s_add_u32 s33, s33, s73
    s_add_u32 m0, s75, 49152
    s_nop 0
    buffer_load_dwordx4 v84, s[8:11], s33 offen offset:0 lds
    v_mfma_f32_32x32x16_bf16 v[48:63], v[100:103], v[104:107], v[48:63]
    ds_read_b128 v[136:139], v90 offset:0
    ds_read_b64_tr_b16 v[132:133], v87 offset:8192
    s_add_u32 m0, s75, 49152
    s_nop 0
    buffer_load_dwordx4 v85, s[8:11], s33 offen offset:1024 lds
    v_mfma_f32_32x32x16_bf16 v[32:47], v[96:99], v[108:111], v[32:47]
    ds_read_b64_tr_b16 v[134:135], v87 offset:9216
    ds_read_b128 v[140:143], v90 offset:4096
    v_mfma_f32_32x32x16_bf16 v[64:79], v[100:103], v[108:111], v[64:79]
    ds_read_b64_tr_b16 v[144:145], v86 offset:12288
    ds_read_b64_tr_b16 v[146:147], v86 offset:13312
    v_mfma_f32_32x32x16_bf16 v[16:31], v[112:115], v[120:123], v[16:31]
    ds_read_b128 v[152:155], v91 offset:0
    ds_read_b64_tr_b16 v[148:149], v87 offset:12288
    v_mfma_f32_32x32x16_bf16 v[48:63], v[116:119], v[120:123], v[48:63]
    ds_read_b64_tr_b16 v[150:151], v87 offset:13312
    ds_read_b128 v[156:159], v91 offset:4096
    v_mfma_f32_32x32x16_bf16 v[32:47], v[112:115], v[124:127], v[32:47]
    v_mfma_f32_32x32x16_bf16 v[64:79], v[116:119], v[124:127], v[64:79]
    s_waitcnt vmcnt(8) lgkmcnt(0)
    s_barrier
    v_mfma_f32_32x32x16_bf16 v[16:31], v[128:131], v[136:139], v[16:31]
    ds_read_b64_tr_b16 v[96:97], v86 offset:16384
    ds_read_b64_tr_b16 v[98:99], v86 offset:17408
    s_add_u32 s33, s33, 114688
    s_add_u32 m0, s75, 57344
    s_nop 0
    buffer_load_dwordx4 v84, s[8:11], s33 offen offset:0 lds
    v_mfma_f32_32x32x16_bf16 v[48:63], v[132:135], v[136:139], v[48:63]
    ds_read_b128 v[104:107], v88 offset:16384
    ds_read_b64_tr_b16 v[100:101], v87 offset:16384
    s_add_u32 m0, s75, 57344
    s_nop 0
    buffer_load_dwordx4 v85, s[8:11], s33 offen offset:1024 lds
    v_mfma_f32_32x32x16_bf16 v[32:47], v[128:131], v[140:143], v[32:47]
    ds_read_b64_tr_b16 v[102:103], v87 offset:17408
    ds_read_b128 v[108:111], v88 offset:20480
    s_add_u32 s3, s71, 3
    s_and_b32 s3, s3, 7
    s_lshl_b32 s3, s3, 7
    s_add_u32 s3, s3, s72
    s_add_u32 m0, s100, 0
    s_nop 0
    buffer_load_dwordx4 v80, s[4:7], s3 offen offset:0 lds
    v_mfma_f32_32x32x16_bf16 v[64:79], v[132:135], v[140:143], v[64:79]
    ds_read_b64_tr_b16 v[112:113], v86 offset:20480
    ds_read_b64_tr_b16 v[114:115], v86 offset:21504
    s_add_u32 m0, s100, 0
    s_nop 0
    buffer_load_dwordx4 v81, s[4:7], s3 offen offset:1024 lds
    v_mfma_f32_32x32x16_bf16 v[16:31], v[144:147], v[152:155], v[16:31]
    ds_read_b128 v[120:123], v89 offset:16384
    ds_read_b64_tr_b16 v[116:117], v87 offset:20480
    v_mfma_f32_32x32x16_bf16 v[48:63], v[148:151], v[152:155], v[48:63]
    ds_read_b64_tr_b16 v[118:119], v87 offset:21504
    ds_read_b128 v[124:127], v89 offset:20480
    v_mfma_f32_32x32x16_bf16 v[32:47], v[144:147], v[156:159], v[32:47]
    v_mfma_f32_32x32x16_bf16 v[64:79], v[148:151], v[156:159], v[64:79]
    s_waitcnt vmcnt(10) lgkmcnt(0)
    s_barrier
    v_mfma_f32_32x32x16_bf16 v[16:31], v[96:99], v[104:107], v[16:31]
    ds_read_b64_tr_b16 v[128:129], v86 offset:24576
    ds_read_b64_tr_b16 v[130:131], v86 offset:25600
    s_add_u32 m0, s100, 0
    s_nop 0
    buffer_load_dwordx4 v82, s[4:7], s3 offen offset:2048 lds
    v_mfma_f32_32x32x16_bf16 v[48:63], v[100:103], v[104:107], v[48:63]
    ds_read_b128 v[136:139], v90 offset:16384
    ds_read_b64_tr_b16 v[132:133], v87 offset:24576
    s_add_u32 m0, s100, 0
    s_nop 0
    buffer_load_dwordx4 v83, s[4:7], s3 offen offset:3072 lds
    v_mfma_f32_32x32x16_bf16 v[32:47], v[96:99], v[108:111], v[32:47]
    ds_read_b64_tr_b16 v[134:135], v87 offset:25600
    ds_read_b128 v[140:143], v90 offset:20480
    s_add_u32 s33, s71, 3
    s_and_b32 s33, s33, 7
    s_mul_i32 s33, s33, 229376
    s_add_u32 s33, s33, s73
    s_add_u32 m0, s75, 65536
    s_nop 0
    buffer_load_dwordx4 v84, s[8:11], s33 offen offset:0 lds
    v_mfma_f32_32x32x16_bf16 v[64:79], v[100:103], v[108:111], v[64:79]
    ds_read_b64_tr_b16 v[144:145], v86 offset:28672
    ds_read_b64_tr_b16 v[146:147], v86 offset:29696
    s_add_u32 m0, s75, 65536
    s_nop 0
    buffer_load_dwordx4 v85, s[8:11], s33 offen offset:1024 lds
    v_mfma_f32_32x32x16_bf16 v[16:31], v[112:115], v[120:123], v[16:31]
    ds_read_b128 v[152:155], v91 offset:16384
    ds_read_b64_tr_b16 v[148:149], v87 offset:28672
    v_mfma_f32_32x32x16_bf16 v[48:63], v[116:119], v[120:123], v[48:63]
    ds_read_b64_tr_b16 v[150:151], v87 offset:29696
    ds_read_b128 v[156:159], v91 offset:20480
    v_mfma_f32_32x32x16_bf16 v[32:47], v[112:115], v[124:127], v[32:47]
    v_mfma_f32_32x32x16_bf16 v[64:79], v[116:119], v[124:127], v[64:79]
    s_waitcnt vmcnt(8) lgkmcnt(0)
    s_barrier
    v_mfma_f32_32x32x16_bf16 v[16:31], v[128:131], v[136:139], v[16:31]
    ds_read_b64_tr_b16 v[96:97], v86 offset:0
    ds_read_b64_tr_b16 v[98:99], v86 offset:1024
    s_add_u32 s33, s33, 114688
    s_add_u32 m0, s75, 73728
    s_nop 0
    buffer_load_dwordx4 v84, s[8:11], s33 offen offset:0 lds
    v_mfma_f32_32x32x16_bf16 v[48:63], v[132:135], v[136:139], v[48:63]
    ds_read_b128 v[104:107], v88 offset:32768
    ds_read_b64_tr_b16 v[100:101], v87 offset:0
    s_add_u32 m0, s75, 73728
    s_nop 0
    buffer_load_dwordx4 v85, s[8:11], s33 offen offset:1024 lds
    v_mfma_f32_32x32x16_bf16 v[32:47], v[128:131], v[140:143], v[32:47]
    ds_read_b64_tr_b16 v[102:103], v87 offset:1024
    ds_read_b128 v[108:111], v88 offset:36864
    s_add_u32 s3, s71, 4
    s_and_b32 s3, s3, 7
    s_lshl_b32 s3, s3, 7
    s_add_u32 s3, s3, s72
    s_add_u32 m0, s100, 16384
    s_nop 0
    buffer_load_dwordx4 v80, s[4:7], s3 offen offset:0 lds
    v_mfma_f32_32x32x16_bf16 v[64:79], v[132:135], v[140:143], v[64:79]
    ds_read_b64_tr_b16 v[112:113], v86 offset:4096
    ds_read_b64_tr_b16 v[114:115], v86 offset:5120
    s_add_u32 m0, s100, 16384
    s_nop 0
    buffer_load_dwordx4 v81, s[4:7], s3 offen offset:1024 lds
    v_mfma_f32_32x32x16_bf16 v[16:31], v[144:147], v[152:155], v[16:31]
    ds_read_b128 v[120:123], v89 offset:32768
    ds_read_b64_tr_b16 v[116:117], v87 offset:4096
    v_mfma_f32_32x32x16_bf16 v[48:63], v[148:151], v[152:155], v[48:63]
    ds_read_b64_tr_b16 v[118:119], v87 offset:5120
    ds_read_b128 v[124:127], v89 offset:36864
    v_mfma_f32_32x32x16_bf16 v[32:47], v[144:147], v[156:159], v[32:47]
    v_mfma_f32_32x32x16_bf16 v[64:79], v[148:151], v[156:159], v[64:79]
    s_waitcnt vmcnt(10) lgkmcnt(0)
    s_barrier
    v_mfma_f32_32x32x16_bf16 v[16:31], v[96:99], v[104:107], v[16:31]
    ds_read_b64_tr_b16 v[128:129], v86 offset:8192
    ds_read_b64_tr_b16 v[130:131], v86 offset:9216
    s_add_u32 m0, s100, 16384
    s_nop 0
    buffer_load_dwordx4 v82, s[4:7], s3 offen offset:2048 lds
    v_mfma_f32_32x32x16_bf16 v[48:63], v[100:103], v[104:107], v[48:63]
    ds_read_b128 v[136:139], v90 offset:32768
    ds_read_b64_tr_b16 v[132:133], v87 offset:8192
    s_add_u32 m0, s100, 16384
    s_nop 0
    buffer_load_dwordx4 v83, s[4:7], s3 offen offset:3072 lds
    v_mfma_f32_32x32x16_bf16 v[32:47], v[96:99], v[108:111], v[32:47]
    ds_read_b64_tr_b16 v[134:135], v87 offset:9216
    ds_read_b128 v[140:143], v90 offset:36864
    s_add_u32 s33, s71, 4
    s_and_b32 s33, s33, 7
    s_mul_i32 s33, s33, 229376
    s_add_u32 s33, s33, s73
    s_add_u32 m0, s75, 49152
    s_nop 0
    buffer_load_dwordx4 v84, s[8:11], s33 offen offset:0 lds
    v_mfma_f32_32x32x16_bf16 v[64:79], v[100:103], v[108:111], v[64:79]
    ds_read_b64_tr_b16 v[144:145], v86 offset:12288
    ds_read_b64_tr_b16 v[146:147], v86 offset:13312
    s_add_u32 m0, s75, 49152
    s_nop 0
    buffer_load_dwordx4 v85, s[8:11], s33 offen offset:1024 lds
    v_mfma_f32_32x32x16_bf16 v[16:31], v[112:115], v[120:123], v[16:31]
    ds_read_b128 v[152:155], v91 offset:32768
    ds_read_b64_tr_b16 v[148:149], v87 offset:12288
    buffer_load_dwordx2 v[8:9], v10, s[24:27], 0 offen sc1
    v_mfma_f32_32x32x16_bf16 v[48:63], v[116:119], v[120:123], v[48:63]
    ds_read_b64_tr_b16 v[150:151], v87 offset:13312
    ds_read_b128 v[156:159], v91 offset:36864
    v_mfma_f32_32x32x16_bf16 v[32:47], v[112:115], v[124:127], v[32:47]
    v_mfma_f32_32x32x16_bf16 v[64:79], v[116:119], v[124:127], v[64:79]
    s_waitcnt vmcnt(9) lgkmcnt(0)
    s_barrier
    v_mfma_f32_32x32x16_bf16 v[16:31], v[128:131], v[136:139], v[16:31]
    ds_read_b64_tr_b16 v[96:97], v86 offset:16384
    ds_read_b64_tr_b16 v[98:99], v86 offset:17408
    s_add_u32 s33, s33, 114688
    s_add_u32 m0, s75, 57344
    s_nop 0
    buffer_load_dwordx4 v84, s[8:11], s33 offen offset:0 lds
    v_mfma_f32_32x32x16_bf16 v[48:63], v[132:135], v[136:139], v[48:63]
    ds_read_b128 v[104:107], v88 offset:0
    ds_read_b64_tr_b16 v[100:101], v87 offset:16384
    s_add_u32 m0, s75, 57344
    s_nop 0
    buffer_load_dwordx4 v85, s[8:11], s33 offen offset:1024 lds
    v_mfma_f32_32x32x16_bf16 v[32:47], v[128:131], v[140:143], v[32:47]
    ds_read_b64_tr_b16 v[102:103], v87 offset:17408
    ds_read_b128 v[108:111], v88 offset:4096
    s_add_u32 s3, s71, 5
    s_and_b32 s3, s3, 7
    s_lshl_b32 s3, s3, 7
    s_add_u32 s3, s3, s72
    s_add_u32 m0, s100, 32768
    s_nop 0
    buffer_load_dwordx4 v80, s[4:7], s3 offen offset:0 lds
    v_mfma_f32_32x32x16_bf16 v[64:79], v[132:135], v[140:143], v[64:79]
    ds_read_b64_tr_b16 v[112:113], v86 offset:20480
    ds_read_b64_tr_b16 v[114:115], v86 offset:21504
    s_add_u32 m0, s100, 32768
    s_nop 0
    buffer_load_dwordx4 v81, s[4:7], s3 offen offset:1024 lds
    v_mfma_f32_32x32x16_bf16 v[16:31], v[144:147], v[152:155], v[16:31]
    ds_read_b128 v[120:123], v89 offset:0
    ds_read_b64_tr_b16 v[116:117], v87 offset:20480
    v_mfma_f32_32x32x16_bf16 v[48:63], v[148:151], v[152:155], v[48:63]
    ds_read_b64_tr_b16 v[118:119], v87 offset:21504
    ds_read_b128 v[124:127], v89 offset:4096
    v_mfma_f32_32x32x16_bf16 v[32:47], v[144:147], v[156:159], v[32:47]
    v_mfma_f32_32x32x16_bf16 v[64:79], v[148:151], v[156:159], v[64:79]
    s_waitcnt vmcnt(11) lgkmcnt(0)
    s_barrier
    v_mfma_f32_32x32x16_bf16 v[16:31], v[96:99], v[104:107], v[16:31]
    ds_read_b64_tr_b16 v[128:129], v86 offset:24576
    ds_read_b64_tr_b16 v[130:131], v86 offset:25600
    s_add_u32 m0, s100, 32768
    s_nop 0
    buffer_load_dwordx4 v82, s[4:7], s3 offen offset:2048 lds
    v_mfma_f32_32x32x16_bf16 v[48:63], v[100:103], v[104:107], v[48:63]
    ds_read_b128 v[136:139], v90 offset:0
    ds_read_b64_tr_b16 v[132:133], v87 offset:24576
    s_add_u32 m0, s100, 32768
    s_nop 0
    buffer_load_dwordx4 v83, s[4:7], s3 offen offset:3072 lds
    v_mfma_f32_32x32x16_bf16 v[32:47], v[96:99], v[108:111], v[32:47]
    ds_read_b64_tr_b16 v[134:135], v87 offset:25600
    ds_read_b128 v[140:143], v90 offset:4096
    s_add_u32 s33, s71, 5
    s_and_b32 s33, s33, 7
    s_mul_i32 s33, s33, 229376
    s_add_u32 s33, s33, s73
    s_add_u32 m0, s75, 65536
    s_nop 0
    buffer_load_dwordx4 v84, s[8:11], s33 offen offset:0 lds
    v_mfma_f32_32x32x16_bf16 v[64:79], v[100:103], v[108:111], v[64:79]
    ds_read_b64_tr_b16 v[144:145], v86 offset:28672
    ds_read_b64_tr_b16 v[146:147], v86 offset:29696
    s_add_u32 m0, s75, 65536
    s_nop 0
    buffer_load_dwordx4 v85, s[8:11], s33 offen offset:1024 lds
    v_mfma_f32_32x32x16_bf16 v[16:31], v[112:115], v[120:123], v[16:31]
    ds_read_b128 v[152:155], v91 offset:0
    ds_read_b64_tr_b16 v[148:149], v87 offset:28672
    v_mfma_f32_32x32x16_bf16 v[48:63], v[116:119], v[120:123], v[48:63]
    ds_read_b64_tr_b16 v[150:151], v87 offset:29696
    ds_read_b128 v[156:159], v91 offset:4096
    v_mfma_f32_32x32x16_bf16 v[32:47], v[112:115], v[124:127], v[32:47]
    v_mfma_f32_32x32x16_bf16 v[64:79], v[116:119], v[124:127], v[64:79]
    s_waitcnt vmcnt(9) lgkmcnt(0)
    s_barrier
    v_mfma_f32_32x32x16_bf16 v[16:31], v[128:131], v[136:139], v[16:31]
    ds_read_b64_tr_b16 v[96:97], v86 offset:0
    ds_read_b64_tr_b16 v[98:99], v86 offset:1024
    s_add_u32 s33, s33, 114688
    s_add_u32 m0, s75, 73728
    s_nop 0
    buffer_load_dwordx4 v84, s[8:11], s33 offen offset:0 lds
    v_mfma_f32_32x32x16_bf16 v[48:63], v[132:135], v[136:139], v[48:63]
    ds_read_b128 v[104:107], v88 offset:16384
    ds_read_b64_tr_b16 v[100:101], v87 offset:0
    s_add_u32 m0, s75, 73728
    s_nop 0
    buffer_load_dwordx4 v85, s[8:11], s33 offen offset:1024 lds
    v_mfma_f32_32x32x16_bf16 v[32:47], v[128:131], v[140:143], v[32:47]
    ds_read_b64_tr_b16 v[102:103], v87 offset:1024
    ds_read_b128 v[108:111], v88 offset:20480
    s_add_u32 s3, s71, 6
    s_and_b32 s3, s3, 7
    s_lshl_b32 s3, s3, 7
    s_add_u32 s3, s3, s72
    s_add_u32 m0, s100, 0
    s_nop 0
    buffer_load_dwordx4 v80, s[4:7], s3 offen offset:0 lds
    v_mfma_f32_32x32x16_bf16 v[64:79], v[132:135], v[140:143], v[64:79]
    ds_read_b64_tr_b16 v[112:113], v86 offset:4096
    ds_read_b64_tr_b16 v[114:115], v86 offset:5120
    s_add_u32 m0, s100, 0
    s_nop 0
    buffer_load_dwordx4 v81, s[4:7], s3 offen offset:1024 lds
    v_mfma_f32_32x32x16_bf16 v[16:31], v[144:147], v[152:155], v[16:31]
    ds_read_b128 v[120:123], v89 offset:16384
    ds_read_b64_tr_b16 v[116:117], v87 offset:4096
    v_mfma_f32_32x32x16_bf16 v[48:63], v[148:151], v[152:155], v[48:63]
    ds_read_b64_tr_b16 v[118:119], v87 offset:5120
    ds_read_b128 v[124:127], v89 offset:20480
    v_mfma_f32_32x32x16_bf16 v[32:47], v[144:147], v[156:159], v[32:47]
    v_mfma_f32_32x32x16_bf16 v[64:79], v[148:151], v[156:159], v[64:79]
    s_waitcnt vmcnt(10) lgkmcnt(0)
    s_barrier
    v_mfma_f32_32x32x16_bf16 v[16:31], v[96:99], v[104:107], v[16:31]
    ds_read_b64_tr_b16 v[128:129], v86 offset:8192
    ds_read_b64_tr_b16 v[130:131], v86 offset:9216
    s_add_u32 m0, s100, 0
    s_nop 0
    buffer_load_dwordx4 v82, s[4:7], s3 offen offset:2048 lds
    v_mfma_f32_32x32x16_bf16 v[48:63], v[100:103], v[104:107], v[48:63]
    ds_read_b128 v[136:139], v90 offset:16384
    ds_read_b64_tr_b16 v[132:133], v87 offset:8192
    s_add_u32 m0, s100, 0
    s_nop 0
    buffer_load_dwordx4 v83, s[4:7], s3 offen offset:3072 lds
    v_mfma_f32_32x32x16_bf16 v[32:47], v[96:99], v[108:111], v[32:47]
    ds_read_b64_tr_b16 v[134:135], v87 offset:9216
    ds_read_b128 v[140:143], v90 offset:20480
    s_add_u32 s33, s71, 6
    s_and_b32 s33, s33, 7
    s_mul_i32 s33, s33, 229376
    s_add_u32 s33, s33, s73
    s_add_u32 m0, s75, 49152
    s_nop 0
    buffer_load_dwordx4 v84, s[8:11], s33 offen offset:0 lds
    v_mfma_f32_32x32x16_bf16 v[64:79], v[100:103], v[108:111], v[64:79]
    ds_read_b64_tr_b16 v[144:145], v86 offset:12288
    ds_read_b64_tr_b16 v[146:147], v86 offset:13312
    s_add_u32 m0, s75, 49152
    s_nop 0
    buffer_load_dwordx4 v85, s[8:11], s33 offen offset:1024 lds
    v_mfma_f32_32x32x16_bf16 v[16:31], v[112:115], v[120:123], v[16:31]
    ds_read_b128 v[152:155], v91 offset:16384
    ds_read_b64_tr_b16 v[148:149], v87 offset:12288
    v_mfma_f32_32x32x16_bf16 v[48:63], v[116:119], v[120:123], v[48:63]
    ds_read_b64_tr_b16 v[150:151], v87 offset:13312
    ds_read_b128 v[156:159], v91 offset:20480
    v_mfma_f32_32x32x16_bf16 v[32:47], v[112:115], v[124:127], v[32:47]
    v_mfma_f32_32x32x16_bf16 v[64:79], v[116:119], v[124:127], v[64:79]
    s_waitcnt vmcnt(8) lgkmcnt(0)
    s_barrier
    v_mfma_f32_32x32x16_bf16 v[16:31], v[128:131], v[136:139], v[16:31]
    ds_read_b64_tr_b16 v[96:97], v86 offset:16384
    ds_read_b64_tr_b16 v[98:99], v86 offset:17408
    s_add_u32 s33, s33, 114688
    s_add_u32 m0, s75, 57344
    s_nop 0
    buffer_load_dwordx4 v84, s[8:11], s33 offen offset:0 lds
    v_mfma_f32_32x32x16_bf16 v[48:63], v[132:135], v[136:139], v[48:63]
    ds_read_b128 v[104:107], v88 offset:32768
    ds_read_b64_tr_b16 v[100:101], v87 offset:16384
    s_add_u32 m0, s75, 57344
    s_nop 0
    buffer_load_dwordx4 v85, s[8:11], s33 offen offset:1024 lds
    v_mfma_f32_32x32x16_bf16 v[32:47], v[128:131], v[140:143], v[32:47]
    ds_read_b64_tr_b16 v[102:103], v87 offset:17408
    ds_read_b128 v[108:111], v88 offset:36864
    s_add_u32 s3, s71, 7
    s_and_b32 s3, s3, 7
    s_lshl_b32 s3, s3, 7
    s_add_u32 s3, s3, s72
    s_add_u32 m0, s100, 16384
    s_nop 0
    buffer_load_dwordx4 v80, s[4:7], s3 offen offset:0 lds
    v_mfma_f32_32x32x16_bf16 v[64:79], v[132:135], v[140:143], v[64:79]
    ds_read_b64_tr_b16 v[112:113], v86 offset:20480
    ds_read_b64_tr_b16 v[114:115], v86 offset:21504
    s_add_u32 m0, s100, 16384
    s_nop 0
    buffer_load_dwordx4 v81, s[4:7], s3 offen offset:1024 lds
    v_mfma_f32_32x32x16_bf16 v[16:31], v[144:147], v[152:155], v[16:31]
    ds_read_b128 v[120:123], v89 offset:32768
    ds_read_b64_tr_b16 v[116:117], v87 offset:20480
    v_mfma_f32_32x32x16_bf16 v[48:63], v[148:151], v[152:155], v[48:63]
    ds_read_b64_tr_b16 v[118:119], v87 offset:21504
    ds_read_b128 v[124:127], v89 offset:36864
    v_mfma_f32_32x32x16_bf16 v[32:47], v[144:147], v[156:159], v[32:47]
    v_mfma_f32_32x32x16_bf16 v[64:79], v[148:151], v[156:159], v[64:79]
    s_waitcnt vmcnt(10) lgkmcnt(0)
    s_barrier
    v_mfma_f32_32x32x16_bf16 v[16:31], v[96:99], v[104:107], v[16:31]
    ds_read_b64_tr_b16 v[128:129], v86 offset:24576
    ds_read_b64_tr_b16 v[130:131], v86 offset:25600
    s_add_u32 m0, s100, 16384
    s_nop 0
    buffer_load_dwordx4 v82, s[4:7], s3 offen offset:2048 lds
    v_mfma_f32_32x32x16_bf16 v[48:63], v[100:103], v[104:107], v[48:63]
    ds_read_b128 v[136:139], v90 offset:32768
    ds_read_b64_tr_b16 v[132:133], v87 offset:24576
    s_add_u32 m0, s100, 16384
    s_nop 0
    buffer_load_dwordx4 v83, s[4:7], s3 offen offset:3072 lds
    v_mfma_f32_32x32x16_bf16 v[32:47], v[96:99], v[108:111], v[32:47]
    ds_read_b64_tr_b16 v[134:135], v87 offset:25600
    ds_read_b128 v[140:143], v90 offset:36864
    s_add_u32 s33, s71, 7
    s_and_b32 s33, s33, 7
    s_mul_i32 s33, s33, 229376
    s_add_u32 s33, s33, s73
    s_add_u32 m0, s75, 65536
    s_nop 0
    buffer_load_dwordx4 v84, s[8:11], s33 offen offset:0 lds
    v_mfma_f32_32x32x16_bf16 v[64:79], v[100:103], v[108:111], v[64:79]
    ds_read_b64_tr_b16 v[144:145], v86 offset:28672
    ds_read_b64_tr_b16 v[146:147], v86 offset:29696
    s_add_u32 m0, s75, 65536
    s_nop 0
    buffer_load_dwordx4 v85, s[8:11], s33 offen offset:1024 lds
    v_mfma_f32_32x32x16_bf16 v[16:31], v[112:115], v[120:123], v[16:31]
    ds_read_b128 v[152:155], v91 offset:32768
    ds_read_b64_tr_b16 v[148:149], v87 offset:28672
    v_mfma_f32_32x32x16_bf16 v[48:63], v[116:119], v[120:123], v[48:63]
    ds_read_b64_tr_b16 v[150:151], v87 offset:29696
    ds_read_b128 v[156:159], v91 offset:36864
    v_mfma_f32_32x32x16_bf16 v[32:47], v[112:115], v[124:127], v[32:47]
    v_mfma_f32_32x32x16_bf16 v[64:79], v[116:119], v[124:127], v[64:79]
    s_waitcnt vmcnt(8) lgkmcnt(0)
    s_barrier
    v_mfma_f32_32x32x16_bf16 v[16:31], v[128:131], v[136:139], v[16:31]
    ds_read_b64_tr_b16 v[96:97], v86 offset:0
    ds_read_b64_tr_b16 v[98:99], v86 offset:1024
    s_add_u32 s33, s33, 114688
    s_add_u32 m0, s75, 73728
    s_nop 0
    buffer_load_dwordx4 v84, s[8:11], s33 offen offset:0 lds
    v_mfma_f32_32x32x16_bf16 v[48:63], v[132:135], v[136:139], v[48:63]
    ds_read_b128 v[104:107], v88 offset:0
    ds_read_b64_tr_b16 v[100:101], v87 offset:0
    s_add_u32 m0, s75, 73728
    s_nop 0
    buffer_load_dwordx4 v85, s[8:11], s33 offen offset:1024 lds
    v_mfma_f32_32x32x16_bf16 v[32:47], v[128:131], v[140:143], v[32:47]
    ds_read_b64_tr_b16 v[102:103], v87 offset:1024
    ds_read_b128 v[108:111], v88 offset:4096
    s_lshl_b32 s101, s68, 14
    s_add_u32 s101, s101, s79
    s_add_u32 m0, s75, 32768
    s_add_u32 s68, s68, 1
    buffer_load_dwordx4 v2, s[20:23], s101 offen lds
    v_mfma_f32_32x32x16_bf16 v[64:79], v[132:135], v[140:143], v[64:79]
    ds_read_b64_tr_b16 v[112:113], v86 offset:4096
    ds_read_b64_tr_b16 v[114:115], v86 offset:5120
    s_add_u32 m0, s75, 32768
    s_cmp_eq_u32 s68, 28
    buffer_load_dwordx4 v3, s[20:23], s101 offen offset:1024 lds
    s_cselect_b32 s68, 0, s68
    v_mfma_f32_32x32x16_bf16 v[16:31], v[144:147], v[152:155], v[16:31]
    ds_read_b128 v[120:123], v89 offset:0
    ds_read_b64_tr_b16 v[116:117], v87 offset:4096
    v_mfma_f32_32x32x16_bf16 v[48:63], v[148:151], v[152:155], v[48:63]
    ds_read_b64_tr_b16 v[118:119], v87 offset:5120
    ds_read_b128 v[124:127], v89 offset:4096
    v_mfma_f32_32x32x16_bf16 v[32:47], v[144:147], v[156:159], v[32:47]
    v_mfma_f32_32x32x16_bf16 v[64:79], v[148:151], v[156:159], v[64:79]
    s_waitcnt vmcnt(10) lgkmcnt(0)
    s_barrier
    v_mfma_f32_32x32x16_bf16 v[16:31], v[96:99], v[104:107], v[16:31]
    ds_read_b64_tr_b16 v[128:129], v86 offset:8192
    ds_read_b64_tr_b16 v[130:131], v86 offset:9216
    s_lshl_b32 s101, s68, 14
    s_add_u32 s101, s101, s79
    s_add_u32 m0, s75, 40960
    s_add_u32 s68, s68, 1
    buffer_load_dwordx4 v2, s[20:23], s101 offen lds
    v_mfma_f32_32x32x16_bf16 v[48:63], v[100:103], v[104:107], v[48:63]
    ds_read_b128 v[136:139], v90 offset:0
    ds_read_b64_tr_b16 v[132:133], v87 offset:8192
    s_add_u32 m0, s75, 40960
    s_cmp_eq_u32 s68, 28
    buffer_load_dwordx4 v3, s[20:23], s101 offen offset:1024 lds
    s_cselect_b32 s68, 0, s68
    v_mfma_f32_32x32x16_bf16 v[32:47], v[96:99], v[108:111], v[32:47]
    ds_read_b64_tr_b16 v[134:135], v87 offset:9216
    ds_read_b128 v[140:143], v90 offset:4096
    s_lshl_b32 s101, s68, 14
    s_add_u32 s101, s101, s79
    s_add_u32 m0, s75, 49152
    s_add_u32 s68, s68, 1
    buffer_load_dwordx4 v2, s[20:23], s101 offen lds
    v_mfma_f32_32x32x16_bf16 v[64:79], v[100:103], v[108:111], v[64:79]
    ds_read_b64_tr_b16 v[144:145], v86 offset:12288
    ds_read_b64_tr_b16 v[146:147], v86 offset:13312
    s_add_u32 m0, s75, 49152
    s_cmp_eq_u32 s68, 28
    buffer_load_dwordx4 v3, s[20:23], s101 offen offset:1024 lds
    s_cselect_b32 s68, 0, s68
    v_mfma_f32_32x32x16_bf16 v[16:31], v[112:115], v[120:123], v[16:31]
    ds_read_b128 v[152:155], v91 offset:0
    ds_read_b64_tr_b16 v[148:149], v87 offset:12288
    v_mfma_f32_32x32x16_bf16 v[48:63], v[116:119], v[120:123], v[48:63]
    ds_read_b64_tr_b16 v[150:151], v87 offset:13312
    ds_read_b128 v[156:159], v91 offset:4096
    v_mfma_f32_32x32x16_bf16 v[32:47], v[112:115], v[124:127], v[32:47]
    v_mfma_f32_32x32x16_bf16 v[64:79], v[116:119], v[124:127], v[64:79]
    s_waitcnt vmcnt(8) lgkmcnt(0)
    s_barrier
    v_mfma_f32_32x32x16_bf16 v[16:31], v[128:131], v[136:139], v[16:31]
    ds_read_b64_tr_b16 v[96:97], v86 offset:16384
    ds_read_b64_tr_b16 v[98:99], v86 offset:17408
    s_lshl_b32 s101, s68, 14
    s_add_u32 s101, s101, s79
    s_add_u32 m0, s75, 57344
    s_add_u32 s68, s68, 1
    buffer_load_dwordx4 v2, s[20:23], s101 offen lds
    v_mfma_f32_32x32x16_bf16 v[48:63], v[132:135], v[136:139], v[48:63]
    ds_read_b128 v[104:107], v88 offset:16384
    ds_read_b64_tr_b16 v[100:101], v87 offset:16384
    s_add_u32 m0, s75, 57344
    s_cmp_eq_u32 s68, 28
    buffer_load_dwordx4 v3, s[20:23], s101 offen offset:1024 lds
    s_cselect_b32 s68, 0, s68
    v_mfma_f32_32x32x16_bf16 v[32:47], v[128:131], v[140:143], v[32:47]
    ds_read_b64_tr_b16 v[102:103], v87 offset:17408
    ds_read_b128 v[108:111], v88 offset:20480
    s_lshl_b32 s101, s68, 14
    s_add_u32 s101, s101, s79
    s_add_u32 m0, s75, 0
    s_add_u32 s68, s68, 1
    buffer_load_dwordx4 v2, s[20:23], s101 offen lds
    v_mfma_f32_32x32x16_bf16 v[64:79], v[132:135], v[140:143], v[64:79]
    ds_read_b64_tr_b16 v[112:113], v86 offset:20480
    ds_read_b64_tr_b16 v[114:115], v86 offset:21504
    s_add_u32 m0, s75, 0
    s_cmp_eq_u32 s68, 28
    buffer_load_dwordx4 v3, s[20:23], s101 offen offset:1024 lds
    s_cselect_b32 s68, 0, s68
    v_mfma_f32_32x32x16_bf16 v[16:31], v[144:147], v[152:155], v[16:31]
    ds_read_b128 v[120:123], v89 offset:16384
    ds_read_b64_tr_b16 v[116:117], v87 offset:20480
    v_mfma_f32_32x32x16_bf16 v[48:63], v[148:151], v[152:155], v[48:63]
    ds_read_b64_tr_b16 v[118:119], v87 offset:21504
    ds_read_b128 v[124:127], v89 offset:20480
    v_mfma_f32_32x32x16_bf16 v[32:47], v[144:147], v[156:159], v[32:47]
    v_mfma_f32_32x32x16_bf16 v[64:79], v[148:151], v[156:159], v[64:79]
    s_waitcnt vmcnt(10) lgkmcnt(0)
    s_barrier
    v_mfma_f32_32x32x16_bf16 v[16:31], v[96:99], v[104:107], v[16:31]
    ds_read_b64_tr_b16 v[128:129], v86 offset:24576
    ds_read_b64_tr_b16 v[130:131], v86 offset:25600
    s_lshl_b32 s101, s68, 14
    s_add_u32 s101, s101, s79
    s_add_u32 m0, s75, 8192
    s_add_u32 s68, s68, 1
    buffer_load_dwordx4 v2, s[20:23], s101 offen lds
    v_mfma_f32_32x32x16_bf16 v[48:63], v[100:103], v[104:107], v[48:63]
    ds_read_b128 v[136:139], v90 offset:16384
    ds_read_b64_tr_b16 v[132:133], v87 offset:24576
    s_add_u32 m0, s75, 8192
    s_cmp_eq_u32 s68, 28
    buffer_load_dwordx4 v3, s[20:23], s101 offen offset:1024 lds
    s_cselect_b32 s68, 0, s68
    v_mfma_f32_32x32x16_bf16 v[32:47], v[96:99], v[108:111], v[32:47]
    ds_read_b64_tr_b16 v[134:135], v87 offset:25600
    ds_read_b128 v[140:143], v90 offset:20480
    s_lshl_b32 s101, s68, 14
    s_add_u32 s101, s101, s79
    s_add_u32 m0, s75, 65536
    s_add_u32 s68, s68, 1
    buffer_load_dwordx4 v2, s[20:23], s101 offen lds
    v_mfma_f32_32x32x16_bf16 v[64:79], v[100:103], v[108:111], v[64:79]
    ds_read_b64_tr_b16 v[144:145], v86 offset:28672
    ds_read_b64_tr_b16 v[146:147], v86 offset:29696
    s_add_u32 m0, s75, 65536
    s_cmp_eq_u32 s68, 28
    buffer_load_dwordx4 v3, s[20:23], s101 offen offset:1024 lds
    s_cselect_b32 s68, 0, s68
    v_mfma_f32_32x32x16_bf16 v[16:31], v[112:115], v[120:123], v[16:31]
    ds_read_b128 v[152:155], v91 offset:16384
    ds_read_b64_tr_b16 v[148:149], v87 offset:28672
    v_mfma_f32_32x32x16_bf16 v[48:63], v[116:119], v[120:123], v[48:63]
    ds_read_b64_tr_b16 v[150:151], v87 offset:29696
    ds_read_b128 v[156:159], v91 offset:20480
    v_mfma_f32_32x32x16_bf16 v[32:47], v[112:115], v[124:127], v[32:47]
    v_mfma_f32_32x32x16_bf16 v[64:79], v[116:119], v[124:127], v[64:79]
    s_waitcnt lgkmcnt(0)
    s_barrier
    v_mfma_f32_32x32x16_bf16 v[16:31], v[128:131], v[136:139], v[16:31]
    v_mfma_f32_32x32x16_bf16 v[48:63], v[132:135], v[136:139], v[48:63]
    v_mfma_f32_32x32x16_bf16 v[32:47], v[128:131], v[140:143], v[32:47]
    v_mfma_f32_32x32x16_bf16 v[64:79], v[132:135], v[140:143], v[64:79]
    v_mfma_f32_32x32x16_bf16 v[16:31], v[144:147], v[152:155], v[16:31]
    v_mfma_f32_32x32x16_bf16 v[48:63], v[148:151], v[152:155], v[48:63]
    v_mfma_f32_32x32x16_bf16 v[32:47], v[144:147], v[156:159], v[32:47]
    v_mfma_f32_32x32x16_bf16 v[64:79], v[148:151], v[156:159], v[64:79]
    s_lshl_b32 s74, s80, 2
    s_and_b32 s76, s70, 2
    s_add_u32 s74, s74, s76
    s_mul_i32 s74, s74, 112
    s_lshl_b32 s76, s81, 3
    s_add_u32 s74, s74, s76
    s_and_b32 s76, s70, 1
    s_lshl_b32 s76, s76, 2
    s_add_u32 s74, s74, s76
    s_lshl_b32 s74, s74, 10
    s_add_u32 s76, s74, 114688
    v_lshlrev_b32 v11, 4, v1
    s_nop 1
    v_max_f32 v160, 0, v16
    v_max_f32 v161, 0, v17
    v_max_f32 v162, 0, v18
    v_max_f32 v163, 0, v19
    v_max_f32 v164, 0, v20
    v_max_f32 v165, 0, v21
    v_max_f32 v166, 0, v22
    v_max_f32 v167, 0, v23
    v_max_f32 v168, 0, v24
    v_max_f32 v169, 0, v25
    v_max_f32 v170, 0, v26
    v_max_f32 v171, 0, v27
    v_max_f32 v172, 0, v28
    v_max_f32 v173, 0, v29
    v_max_f32 v174, 0, v30
    v_max_f32 v175, 0, v31
    v_pk_mul_f32 v[160:161], v[160:161], v[160:161]
    v_pk_mul_f32 v[162:163], v[162:163], v[162:163]
    v_pk_mul_f32 v[164:165], v[164:165], v[164:165]
    v_pk_mul_f32 v[166:167], v[166:167], v[166:167]
    v_pk_mul_f32 v[168:169], v[168:169], v[168:169]
    v_pk_mul_f32 v[170:171], v[170:171], v[170:171]
    v_pk_mul_f32 v[172:173], v[172:173], v[172:173]
    v_pk_mul_f32 v[174:175], v[174:175], v[174:175]
    v_cvt_pk_bf16_f32 v96, v160, v161
    v_cvt_pk_bf16_f32 v97, v162, v163
    v_cvt_pk_bf16_f32 v98, v164, v165
    v_cvt_pk_bf16_f32 v99, v166, v167
    v_cvt_pk_bf16_f32 v100, v168, v169
    v_cvt_pk_bf16_f32 v101, v170, v171
    v_cvt_pk_bf16_f32 v102, v172, v173
    v_cvt_pk_bf16_f32 v103, v174, v175
    buffer_store_dwordx4 v[96:99], v11, s[16:19], s74 offen offset:0 sc1
    buffer_store_dwordx4 v[100:103], v11, s[16:19], s74 offen offset:1024 sc1
    v_max_f32 v160, 0, v48
    v_max_f32 v161, 0, v49
    v_max_f32 v162, 0, v50
    v_max_f32 v163, 0, v51
    v_max_f32 v164, 0, v52
    v_max_f32 v165, 0, v53
    v_max_f32 v166, 0, v54
    v_max_f32 v167, 0, v55
    v_max_f32 v168, 0, v56
    v_max_f32 v169, 0, v57
    v_max_f32 v170, 0, v58
    v_max_f32 v171, 0, v59
    v_max_f32 v172, 0, v60
    v_max_f32 v173, 0, v61
    v_max_f32 v174, 0, v62
    v_max_f32 v175, 0, v63
    v_pk_mul_f32 v[160:161], v[160:161], v[160:161]
    v_pk_mul_f32 v[162:163], v[162:163], v[162:163]
    v_pk_mul_f32 v[164:165], v[164:165], v[164:165]
    v_pk_mul_f32 v[166:167], v[166:167], v[166:167]
    v_pk_mul_f32 v[168:169], v[168:169], v[168:169]
    v_pk_mul_f32 v[170:171], v[170:171], v[170:171]
    v_pk_mul_f32 v[172:173], v[172:173], v[172:173]
    v_pk_mul_f32 v[174:175], v[174:175], v[174:175]
    v_cvt_pk_bf16_f32 v104, v160, v161
    v_cvt_pk_bf16_f32 v105, v162, v163
    v_cvt_pk_bf16_f32 v106, v164, v165
    v_cvt_pk_bf16_f32 v107, v166, v167
    v_cvt_pk_bf16_f32 v108, v168, v169
    v_cvt_pk_bf16_f32 v109, v170, v171
    v_cvt_pk_bf16_f32 v110, v172, v173
    v_cvt_pk_bf16_f32 v111, v174, v175
    buffer_store_dwordx4 v[104:107], v11, s[16:19], s74 offen offset:2048 sc1
    buffer_store_dwordx4 v[108:111], v11, s[16:19], s74 offen offset:3072 sc1
    v_max_f32 v160, 0, v32
    v_max_f32 v161, 0, v33
    v_max_f32 v162, 0, v34
    v_max_f32 v163, 0, v35
    v_max_f32 v164, 0, v36
    v_max_f32 v165, 0, v37
    v_max_f32 v166, 0, v38
    v_max_f32 v167, 0, v39
    v_max_f32 v168, 0, v40
    v_max_f32 v169, 0, v41
    v_max_f32 v170, 0, v42
    v_max_f32 v171, 0, v43
    v_max_f32 v172, 0, v44
    v_max_f32 v173, 0, v45
    v_max_f32 v174, 0, v46
    v_max_f32 v175, 0, v47
    v_pk_mul_f32 v[160:161], v[160:161], v[160:161]
    v_pk_mul_f32 v[162:163], v[162:163], v[162:163]
    v_pk_mul_f32 v[164:165], v[164:165], v[164:165]
    v_pk_mul_f32 v[166:167], v[166:167], v[166:167]
    v_pk_mul_f32 v[168:169], v[168:169], v[168:169]
    v_pk_mul_f32 v[170:171], v[170:171], v[170:171]
    v_pk_mul_f32 v[172:173], v[172:173], v[172:173]
    v_pk_mul_f32 v[174:175], v[174:175], v[174:175]
    v_cvt_pk_bf16_f32 v112, v160, v161
    v_cvt_pk_bf16_f32 v113, v162, v163
    v_cvt_pk_bf16_f32 v114, v164, v165
    v_cvt_pk_bf16_f32 v115, v166, v167
    v_cvt_pk_bf16_f32 v116, v168, v169
    v_cvt_pk_bf16_f32 v117, v170, v171
    v_cvt_pk_bf16_f32 v118, v172, v173
    v_cvt_pk_bf16_f32 v119, v174, v175
    buffer_store_dwordx4 v[112:115], v11, s[16:19], s76 offen offset:0 sc1
    buffer_store_dwordx4 v[116:119], v11, s[16:19], s76 offen offset:1024 sc1
    v_max_f32 v160, 0, v64
    v_max_f32 v161, 0, v65
    v_max_f32 v162, 0, v66
    v_max_f32 v163, 0, v67
    v_max_f32 v164, 0, v68
    v_max_f32 v165, 0, v69
    v_max_f32 v166, 0, v70
    v_max_f32 v167, 0, v71
    v_max_f32 v168, 0, v72
    v_max_f32 v169, 0, v73
    v_max_f32 v170, 0, v74
    v_max_f32 v171, 0, v75
    v_max_f32 v172, 0, v76
    v_max_f32 v173, 0, v77
    v_max_f32 v174, 0, v78
    v_max_f32 v175, 0, v79
    v_pk_mul_f32 v[160:161], v[160:161], v[160:161]
    v_pk_mul_f32 v[162:163], v[162:163], v[162:163]
    v_pk_mul_f32 v[164:165], v[164:165], v[164:165]
    v_pk_mul_f32 v[166:167], v[166:167], v[166:167]
    v_pk_mul_f32 v[168:169], v[168:169], v[168:169]
    v_pk_mul_f32 v[170:171], v[170:171], v[170:171]
    v_pk_mul_f32 v[172:173], v[172:173], v[172:173]
    v_pk_mul_f32 v[174:175], v[174:175], v[174:175]
    v_cvt_pk_bf16_f32 v120, v160, v161
    v_cvt_pk_bf16_f32 v121, v162, v163
    v_cvt_pk_bf16_f32 v122, v164, v165
    v_cvt_pk_bf16_f32 v123, v166, v167
    v_cvt_pk_bf16_f32 v124, v168, v169
    v_cvt_pk_bf16_f32 v125, v170, v171
    v_cvt_pk_bf16_f32 v126, v172, v173
    v_cvt_pk_bf16_f32 v127, v174, v175
    buffer_store_dwordx4 v[120:123], v11, s[16:19], s76 offen offset:2048 sc1
    buffer_store_dwordx4 v[124:127], v11, s[16:19], s76 offen offset:3072 sc1
    s_lshl_b32 s101, s68, 14
    s_add_u32 s101, s101, s79
    s_add_u32 m0, s75, 73728
    s_add_u32 s68, s68, 1
    buffer_load_dwordx4 v2, s[20:23], s101 offen lds
    s_add_u32 m0, s75, 73728
    s_cmp_eq_u32 s68, 28
    buffer_load_dwordx4 v3, s[20:23], s101 offen offset:1024 lds
    s_cselect_b32 s68, 0, s68
    s_lshl_b32 s101, s68, 14
    s_add_u32 s101, s101, s79
    s_add_u32 m0, s75, 16384
    s_add_u32 s68, s68, 1
    buffer_load_dwordx4 v2, s[20:23], s101 offen lds
    s_add_u32 m0, s75, 16384
    s_cmp_eq_u32 s68, 28
    buffer_load_dwordx4 v3, s[20:23], s101 offen offset:1024 lds
    s_cselect_b32 s68, 0, s68
    s_lshl_b32 s101, s68, 14
    s_add_u32 s101, s101, s79
    s_add_u32 m0, s75, 24576
    s_add_u32 s68, s68, 1
    buffer_load_dwordx4 v2, s[20:23], s101 offen lds
    s_add_u32 m0, s75, 24576
    s_cmp_eq_u32 s68, 28
    buffer_load_dwordx4 v3, s[20:23], s101 offen offset:1024 lds
    s_cselect_b32 s68, 0, s68
    v_subrev_u32 v14, 0x4000, v4
    v_subrev_u32 v15, 0x4000, v5
    s_waitcnt vmcnt(26)
    ds_read_b64_tr_b16 v[80:81], v4 offset:16384
    ds_read_b64_tr_b16 v[82:83], v4 offset:17408
    ds_read_b64_tr_b16 v[84:85], v5 offset:16384
    ds_read_b64_tr_b16 v[86:87], v5 offset:17408
    s_waitcnt lgkmcnt(0)
    s_lshl_b32 s101, s68, 14
    s_add_u32 s101, s101, s79
    s_add_u32 m0, s75, 32768
    s_add_u32 s68, s68, 1
    buffer_load_dwordx4 v2, s[20:23], s101 offen lds
    s_add_u32 m0, s75, 32768
    s_cmp_eq_u32 s68, 28
    buffer_load_dwordx4 v3, s[20:23], s101 offen offset:1024 lds
    s_cselect_b32 s68, 0, s68
    s_waitcnt vmcnt(26)
    ds_read_b64_tr_b16 v[88:89], v4 offset:24576
    ds_read_b64_tr_b16 v[90:91], v4 offset:25600
    ds_read_b64_tr_b16 v[92:93], v5 offset:24576
    ds_read_b64_tr_b16 v[94:95], v5 offset:25600
    s_waitcnt lgkmcnt(0)
    s_lshl_b32 s101, s68, 14
    s_add_u32 s101, s101, s79
    s_add_u32 m0, s75, 40960
    s_add_u32 s68, s68, 1
    buffer_load_dwordx4 v2, s[20:23], s101 offen lds
    s_add_u32 m0, s75, 40960
    s_cmp_eq_u32 s68, 28
    buffer_load_dwordx4 v3, s[20:23], s101 offen offset:1024 lds
    s_cselect_b32 s68, 0, s68
    s_waitcnt vmcnt(26)
    ds_read_b64_tr_b16 v[96:97], v4 offset:32768
    ds_read_b64_tr_b16 v[98:99], v4 offset:33792
    ds_read_b64_tr_b16 v[100:101], v5 offset:32768
    ds_read_b64_tr_b16 v[102:103], v5 offset:33792
    s_waitcnt lgkmcnt(0)
    s_lshl_b32 s101, s68, 14
    s_add_u32 s101, s101, s79
    s_add_u32 m0, s75, 49152
    s_add_u32 s68, s68, 1
    buffer_load_dwordx4 v2, s[20:23], s101 offen lds
    s_add_u32 m0, s75, 49152
    s_cmp_eq_u32 s68, 28
    buffer_load_dwordx4 v3, s[20:23], s101 offen offset:1024 lds
    s_cselect_b32 s68, 0, s68
    s_mov_b32 s69, 0
tok_4:
    v_readfirstlane_b32 s34, v8
    v_readfirstlane_b32 s35, v9
    s_nop 1
    s_cmp_lg_u32 s34, 0
    s_cbranch_scc1 tokd_5
    s_add_u32 s69, s69, 1
    s_cmp_ge_u32 s69, 262144
    s_cbranch_scc1 tokd_5
    buffer_load_dwordx2 v[8:9], v10, s[24:27], 0 offen sc1
    s_waitcnt vmcnt(0)
    s_branch tok_4
tokd_5:
    s_lshl_b32 s74, s80, 11
    s_lshl_b32 s76, s81, 7
    s_add_u32 s76, s74, s76
    s_lshl_b32 s74, s70, 5
    s_add_u32 s76, s74, s76
    s_waitcnt vmcnt(12)
    s_mov_b64 exec, 1
    buffer_store_dwordx2 v[8:9], v10, s[28:31], s76 offen sc1
    s_mov_b64 exec, -1
    s_branch g1merge_3
g1skip_2:
    v_lshrrev_b32 v11, 3, v1
    v_lshlrev_b32 v11, 10, v11
    v_bfe_u32 v12, v1, 4, 1
    v_lshlrev_b32 v12, 2, v12
    v_and_b32 v13, 7, v1
    v_xor_b32 v12, v12, v13
    v_lshl_add_u32 v2, v12, 4, v11
    v_add_u32 v3, 7168, v2
    s_and_b32 s74, s70, 1
    s_mul_i32 s74, s74, 114688
    v_lshl_add_u32 v6, v1, 4, s74
    s_sub_u32 s74, 114688, s74
    v_lshl_add_u32 v7, v1, 4, s74
    s_mul_i32 s78, s82, 229376
    s_mul_i32 s74, s70, 28672
    s_add_u32 s78, s78, s74
    s_lshl_b32 s79, s83, 7
    s_mul_i32 s74, s70, 458752
    s_add_u32 s79, s79, s74
    s_mul_i32 s77, s82, 7
    s_lshr_b32 s77, s77, 3
    s_mul_i32 s74, s83, 7
    s_lshr_b32 s74, s74, 1
    s_add_u32 s77, s77, s74
    s_cmp_ge_u32 s77, 28
    s_cselect_b32 s74, 28, 0
    s_sub_u32 s77, s77, s74
    s_mov_b32 s68, s77
    v_bfe_u32 v11, v1, 2, 2
    v_lshrrev_b32 v12, 5, v1
    v_lshl_add_u32 v13, v12, 2, v11
    v_lshlrev_b32 v13, 7, v13
    v_and_b32 v14, 1, v1
    v_lshl_add_u32 v13, v14, 3, v13
    v_add_u32 v13, s75, v13
    v_bfe_u32 v14, v1, 4, 1
    v_bfe_u32 v15, v1, 1, 1
    v_lshl_add_u32 v14, v14, 1, v15
    v_bfe_u32 v15, v1, 3, 1
    s_lshr_b32 s74, s70, 1
    v_xor_b32 v15, s74, v15
    v_lshl_add_u32 v14, v15, 2, v14
    v_lshl_add_u32 v4, v14, 4, v13
    v_add_u32 v4, 0x4000, v4
    v_xor_b32 v5, 64, v4
    s_sub_u32 s74, s76, 28
    s_mul_i32 s74, s74, 458752
    v_lshl_add_u32 v11, v0, 7, s74
    s_and_b32 s74, s2, 7
    s_mul_i32 s74, s74, 7
    s_lshr_b32 s74, s74, 2
    s_lshl_b32 s74, s74, 15
    buffer_load_dword v16, v11, s[20:23], s74 offen
    s_add_u32 s74, s74, 32768
    s_cmp_eq_u32 s74, 458752
    s_cselect_b32 s74, 0, s74
    s_waitcnt vmcnt(2)
    buffer_load_dword v17, v11, s[20:23], s74 offen
    s_add_u32 s74, s74, 32768
    s_cmp_eq_u32 s74, 458752
    s_cselect_b32 s74, 0, s74
    s_waitcnt vmcnt(2)
    buffer_load_dword v18, v11, s[20:23], s74 offen
    s_add_u32 s74, s74, 32768
    s_cmp_eq_u32 s74, 458752
    s_cselect_b32 s74, 0, s74
    s_waitcnt vmcnt(2)
    buffer_load_dword v19, v11, s[20:23], s74 offen
    s_add_u32 s74, s74, 32768
    s_cmp_eq_u32 s74, 458752
    s_cselect_b32 s74, 0, s74
    s_waitcnt vmcnt(2)
    buffer_load_dword v20, v11, s[20:23], s74 offen
    s_add_u32 s74, s74, 32768
    s_cmp_eq_u32 s74, 458752
    s_cselect_b32 s74, 0, s74
    s_waitcnt vmcnt(2)
    buffer_load_dword v21, v11, s[20:23], s74 offen
    s_add_u32 s74, s74, 32768
    s_cmp_eq_u32 s74, 458752
    s_cselect_b32 s74, 0, s74
    s_waitcnt vmcnt(2)
    buffer_load_dword v22, v11, s[20:23], s74 offen
    s_add_u32 s74, s74, 32768
    s_cmp_eq_u32 s74, 458752
    s_cselect_b32 s74, 0, s74
    s_waitcnt vmcnt(2)
    buffer_load_dword v23, v11, s[20:23], s74 offen
    s_add_u32 s74, s74, 32768
    s_cmp_eq_u32 s74, 458752
    s_cselect_b32 s74, 0, s74
    s_waitcnt vmcnt(2)
    buffer_load_dword v24, v11, s[20:23], s74 offen
    s_add_u32 s74, s74, 32768
    s_cmp_eq_u32 s74, 458752
    s_cselect_b32 s74, 0, s74
    s_waitcnt vmcnt(2)
    buffer_load_dword v25, v11, s[20:23], s74 offen
    s_add_u32 s74, s74, 32768
    s_cmp_eq_u32 s74, 458752
    s_cselect_b32 s74, 0, s74
    s_waitcnt vmcnt(2)
    buffer_load_dword v26, v11, s[20:23], s74 offen
    s_add_u32 s74, s74, 32768
    s_cmp_eq_u32 s74, 458752
    s_cselect_b32 s74, 0, s74
    s_waitcnt vmcnt(2)
    buffer_load_dword v27, v11, s[20:23], s74 offen
    s_add_u32 s74, s74, 32768
    s_cmp_eq_u32 s74, 458752
    s_cselect_b32 s74, 0, s74
    s_waitcnt vmcnt(2)
    buffer_load_dword v28, v11, s[20:23], s74 offen
    s_add_u32 s74, s74, 32768
    s_cmp_eq_u32 s74, 458752
    s_cselect_b32 s74, 0, s74
    s_waitcnt vmcnt(2)
    buffer_load_dword v29, v11, s[20:23], s74 offen
    s_add_u32 s74, s74, 32768
    s_cmp_eq_u32 s74, 458752
    s_cselect_b32 s74, 0, s74
    s_waitcnt vmcnt(2)
    s_lshl_b32 s101, s68, 14
    s_add_u32 s101, s101, s79
    s_add_u32 m0, s75, 32768
    s_add_u32 s68, s68, 1
    buffer_load_dwordx4 v2, s[20:23], s101 offen lds
    s_add_u32 m0, s75, 32768
    s_cmp_eq_u32 s68, 28
    buffer_load_dwordx4 v3, s[20:23], s101 offen offset:1024 lds
    s_cselect_b32 s68, 0, s68
    s_lshl_b32 s101, s68, 14
    s_add_u32 s101, s101, s79
    s_add_u32 m0, s75, 40960
    s_add_u32 s68, s68, 1
    buffer_load_dwordx4 v2, s[20:23], s101 offen lds
    s_add_u32 m0, s75, 40960
    s_cmp_eq_u32 s68, 28
    buffer_load_dwordx4 v3, s[20:23], s101 offen offset:1024 lds
    s_cselect_b32 s68, 0, s68
    s_lshl_b32 s101, s68, 14
    s_add_u32 s101, s101, s79
    s_add_u32 m0, s75, 49152
    s_add_u32 s68, s68, 1
    buffer_load_dwordx4 v2, s[20:23], s101 offen lds
    s_add_u32 m0, s75, 49152
    s_cmp_eq_u32 s68, 28
    buffer_load_dwordx4 v3, s[20:23], s101 offen offset:1024 lds
    s_cselect_b32 s68, 0, s68
    s_lshl_b32 s101, s68, 14
    s_add_u32 s101, s101, s79
    s_add_u32 m0, s75, 57344
    s_add_u32 s68, s68, 1
    buffer_load_dwordx4 v2, s[20:23], s101 offen lds
    s_add_u32 m0, s75, 57344
    s_cmp_eq_u32 s68, 28
    buffer_load_dwordx4 v3, s[20:23], s101 offen offset:1024 lds
    s_cselect_b32 s68, 0, s68
    s_lshl_b32 s101, s68, 14
    s_add_u32 s101, s101, s79
    s_add_u32 m0, s75, 0
    s_add_u32 s68, s68, 1
    buffer_load_dwordx4 v2, s[20:23], s101 offen lds
    s_add_u32 m0, s75, 0
    s_cmp_eq_u32 s68, 28
    buffer_load_dwordx4 v3, s[20:23], s101 offen offset:1024 lds
    s_cselect_b32 s68, 0, s68
    s_lshl_b32 s101, s68, 14
    s_add_u32 s101, s101, s79
    s_add_u32 m0, s75, 8192
    s_add_u32 s68, s68, 1
    buffer_load_dwordx4 v2, s[20:23], s101 offen lds
    s_add_u32 m0, s75, 8192
    s_cmp_eq_u32 s68, 28
    buffer_load_dwordx4 v3, s[20:23], s101 offen offset:1024 lds
    s_cselect_b32 s68, 0, s68
    s_lshl_b32 s101, s68, 14
    s_add_u32 s101, s101, s79
    s_add_u32 m0, s75, 65536
    s_add_u32 s68, s68, 1
    buffer_load_dwordx4 v2, s[20:23], s101 offen lds
    s_add_u32 m0, s75, 65536
    s_cmp_eq_u32 s68, 28
    buffer_load_dwordx4 v3, s[20:23], s101 offen offset:1024 lds
    s_cselect_b32 s68, 0, s68
    s_lshl_b32 s101, s68, 14
    s_add_u32 s101, s101, s79
    s_add_u32 m0, s75, 73728
    s_add_u32 s68, s68, 1
    buffer_load_dwordx4 v2, s[20:23], s101 offen lds
    s_add_u32 m0, s75, 73728
    s_cmp_eq_u32 s68, 28
    buffer_load_dwordx4 v3, s[20:23], s101 offen offset:1024 lds
    s_cselect_b32 s68, 0, s68
    s_lshl_b32 s101, s68, 14
    s_add_u32 s101, s101, s79
    s_add_u32 m0, s75, 16384
    s_add_u32 s68, s68, 1
    buffer_load_dwordx4 v2, s[20:23], s101 offen lds
    s_add_u32 m0, s75, 16384
    s_cmp_eq_u32 s68, 28
    buffer_load_dwordx4 v3, s[20:23], s101 offen offset:1024 lds
    s_cselect_b32 s68, 0, s68
    s_lshl_b32 s101, s68, 14
    s_add_u32 s101, s101, s79
    s_add_u32 m0, s75, 24576
    s_add_u32 s68, s68, 1
    buffer_load_dwordx4 v2, s[20:23], s101 offen lds
    s_add_u32 m0, s75, 24576
    s_cmp_eq_u32 s68, 28
    buffer_load_dwordx4 v3, s[20:23], s101 offen offset:1024 lds
    s_cselect_b32 s68, 0, s68
    v_mov_b32 v8, 0
    v_mov_b32 v9, 0
    s_nop 0
    s_mov_b32 s69, 0
tok_6:
    v_readfirstlane_b32 s34, v8
    v_readfirstlane_b32 s35, v9
    s_nop 1
    s_cmp_lg_u32 s34, 0
    s_cbranch_scc1 tokd_7
    s_add_u32 s69, s69, 1
    s_cmp_ge_u32 s69, 262144
    s_cbranch_scc1 tokd_7
    buffer_load_dwordx2 v[8:9], v10, s[24:27], 0 offen sc1
    s_waitcnt vmcnt(0)
    s_branch tok_6
tokd_7:
    v_subrev_u32 v14, 0x4000, v4
    v_subrev_u32 v15, 0x4000, v5
    s_waitcnt vmcnt(18)
    ds_read_b64_tr_b16 v[80:81], v4 offset:16384
    ds_read_b64_tr_b16 v[82:83], v4 offset:17408
    ds_read_b64_tr_b16 v[84:85], v5 offset:16384
    ds_read_b64_tr_b16 v[86:87], v5 offset:17408
    s_waitcnt lgkmcnt(0)
    s_lshl_b32 s101, s68, 14
    s_add_u32 s101, s101, s79
    s_add_u32 m0, s75, 32768
    s_add_u32 s68, s68, 1
    buffer_load_dwordx4 v2, s[20:23], s101 offen lds
    s_add_u32 m0, s75, 32768
    s_cmp_eq_u32 s68, 28
    buffer_load_dwordx4 v3, s[20:23], s101 offen offset:1024 lds
    s_cselect_b32 s68, 0, s68
    s_waitcnt vmcnt(18)
    ds_read_b64_tr_b16 v[88:89], v4 offset:24576
    ds_read_b64_tr_b16 v[90:91], v4 offset:25600
    ds_read_b64_tr_b16 v[92:93], v5 offset:24576
    ds_read_b64_tr_b16 v[94:95], v5 offset:25600
    s_waitcnt lgkmcnt(0)
    s_lshl_b32 s101, s68, 14
    s_add_u32 s101, s101, s79
    s_add_u32 m0, s75, 40960
    s_add_u32 s68, s68, 1
    buffer_load_dwordx4 v2, s[20:23], s101 offen lds
    s_add_u32 m0, s75, 40960
    s_cmp_eq_u32 s68, 28
    buffer_load_dwordx4 v3, s[20:23], s101 offen offset:1024 lds
    s_cselect_b32 s68, 0, s68
    s_waitcnt vmcnt(18)
    ds_read_b64_tr_b16 v[96:97], v4 offset:32768
    ds_read_b64_tr_b16 v[98:99], v4 offset:33792
    ds_read_b64_tr_b16 v[100:101], v5 offset:32768
    ds_read_b64_tr_b16 v[102:103], v5 offset:33792
    s_waitcnt lgkmcnt(0)
    s_lshl_b32 s101, s68, 14
    s_add_u32 s101, s101, s79
    s_add_u32 m0, s75, 49152
    s_add_u32 s68, s68, 1
    buffer_load_dwordx4 v2, s[20:23], s101 offen lds
    s_add_u32 m0, s75, 49152
    s_cmp_eq_u32 s68, 28
    buffer_load_dwordx4 v3, s[20:23], s101 offen offset:1024 lds
    s_cselect_b32 s68, 0, s68
g1merge_3:
    s_setprio 0
    s_mov_b32 s12, s58
    s_mov_b32 s13, s59
    s_mov_b32 s14, 1024
    s_mov_b32 s15, 0x00020000
    s_lshl_b32 s74, s83, 6
    s_lshr_b32 s76, s70, 1
    s_lshl_b32 s76, s76, 5
    s_add_u32 s72, s74, s76
    s_lshl_b32 s74, s82, 6
    s_and_b32 s76, s70, 1
    s_lshl_b32 s76, s76, 5
    s_add_u32 s73, s74, s76
    v_lshrrev_b32 v13, 5, v1
    v_lshlrev_b32 v13, 3, v13
    s_lshl_b32 s74, s72, 1
    buffer_load_dwordx2 v[240:241], v13, s[12:15], s74 offen offset:0
    buffer_load_dwordx2 v[242:243], v13, s[12:15], s74 offen offset:16
    buffer_load_dwordx2 v[244:245], v13, s[12:15], s74 offen offset:32
    buffer_load_dwordx2 v[246:247], v13, s[12:15], s74 offen offset:48
    s_waitcnt vmcnt(22)
    ds_read_b64_tr_b16 v[104:105], v4 offset:40960
    ds_read_b64_tr_b16 v[106:107], v4 offset:41984
    ds_read_b64_tr_b16 v[108:109], v5 offset:40960
    ds_read_b64_tr_b16 v[110:111], v5 offset:41984
    s_waitcnt lgkmcnt(0)
    s_lshl_b32 s101, s68, 14
    s_add_u32 s101, s101, s79
    s_add_u32 m0, s75, 57344
    s_add_u32 s68, s68, 1
    buffer_load_dwordx4 v2, s[20:23], s101 offen lds
    s_add_u32 m0, s75, 57344
    s_cmp_eq_u32 s68, 28
    buffer_load_dwordx4 v3, s[20:23], s101 offen offset:1024 lds
    s_cselect_b32 s68, 0, s68
    s_waitcnt vmcnt(22)
    ds_read_b64_tr_b16 v[112:113], v14 offset:0
    ds_read_b64_tr_b16 v[114:115], v14 offset:1024
    ds_read_b64_tr_b16 v[116:117], v15 offset:0
    ds_read_b64_tr_b16 v[118:119], v15 offset:1024
    s_waitcnt lgkmcnt(0)
    s_lshl_b32 s101, s68, 14
    s_add_u32 s101, s101, s79
    s_add_u32 m0, s75, 0
    s_add_u32 s68, s68, 1
    buffer_load_dwordx4 v2, s[20:23], s101 offen lds
    s_add_u32 m0, s75, 0
    s_cmp_eq_u32 s68, 28
    buffer_load_dwordx4 v3, s[20:23], s101 offen offset:1024 lds
    s_cselect_b32 s68, 0, s68
    s_waitcnt vmcnt(22)
    ds_read_b64_tr_b16 v[120:121], v14 offset:8192
    ds_read_b64_tr_b16 v[122:123], v14 offset:9216
    ds_read_b64_tr_b16 v[124:125], v15 offset:8192
    ds_read_b64_tr_b16 v[126:127], v15 offset:9216
    s_waitcnt lgkmcnt(0)
    s_lshl_b32 s101, s68, 14
    s_add_u32 s101, s101, s79
    s_add_u32 m0, s75, 8192
    s_add_u32 s68, s68, 1
    buffer_load_dwordx4 v2, s[20:23], s101 offen lds
    s_add_u32 m0, s75, 8192
    s_cmp_eq_u32 s68, 28
    buffer_load_dwordx4 v3, s[20:23], s101 offen offset:1024 lds
    s_cselect_b32 s68, 0, s68
    s_waitcnt vmcnt(22)
    ds_read_b64_tr_b16 v[128:129], v4 offset:49152
    ds_read_b64_tr_b16 v[130:131], v4 offset:50176
    ds_read_b64_tr_b16 v[132:133], v5 offset:49152
    ds_read_b64_tr_b16 v[134:135], v5 offset:50176
    s_waitcnt lgkmcnt(0)
    s_lshl_b32 s101, s68, 14
    s_add_u32 s101, s101, s79
    s_add_u32 m0, s75, 65536
    s_add_u32 s68, s68, 1
    buffer_load_dwordx4 v2, s[20:23], s101 offen lds
    s_add_u32 m0, s75, 65536
    s_cmp_eq_u32 s68, 28
    buffer_load_dwordx4 v3, s[20:23], s101 offen offset:1024 lds
    s_cselect_b32 s68, 0, s68
    s_waitcnt vmcnt(22)
    ds_read_b64_tr_b16 v[136:137], v4 offset:57344
    ds_read_b64_tr_b16 v[138:139], v4 offset:58368
    ds_read_b64_tr_b16 v[140:141], v5 offset:57344
    ds_read_b64_tr_b16 v[142:143], v5 offset:58368
    s_waitcnt lgkmcnt(0)
    s_lshl_b32 s101, s68, 14
    s_add_u32 s101, s101, s79
    s_add_u32 m0, s75, 73728
    s_add_u32 s68, s68, 1
    buffer_load_dwordx4 v2, s[20:23], s101 offen lds
    s_add_u32 m0, s75, 73728
    s_cmp_eq_u32 s68, 28
    buffer_load_dwordx4 v3, s[20:23], s101 offen offset:1024 lds
    s_cselect_b32 s68, 0, s68
    s_waitcnt vmcnt(22)
    ds_read_b64_tr_b16 v[144:145], v4 offset:0
    ds_read_b64_tr_b16 v[146:147], v4 offset:1024
    ds_read_b64_tr_b16 v[148:149], v5 offset:0
    ds_read_b64_tr_b16 v[150:151], v5 offset:1024
    s_waitcnt lgkmcnt(0)
    s_lshl_b32 s101, s68, 14
    s_add_u32 s101, s101, s79
    s_add_u32 m0, s75, 16384
    s_add_u32 s68, s68, 1
    buffer_load_dwordx4 v2, s[20:23], s101 offen lds
    s_add_u32 m0, s75, 16384
    s_cmp_eq_u32 s68, 28
    buffer_load_dwordx4 v3, s[20:23], s101 offen offset:1024 lds
    s_cselect_b32 s68, 0, s68
    s_waitcnt vmcnt(22)
    ds_read_b64_tr_b16 v[152:153], v4 offset:8192
    ds_read_b64_tr_b16 v[154:155], v4 offset:9216
    ds_read_b64_tr_b16 v[156:157], v5 offset:8192
    ds_read_b64_tr_b16 v[158:159], v5 offset:9216
    s_waitcnt lgkmcnt(0)
    s_lshl_b32 s101, s68, 14
    s_add_u32 s101, s101, s79
    s_add_u32 m0, s75, 24576
    s_add_u32 s68, s68, 1
    buffer_load_dwordx4 v2, s[20:23], s101 offen lds
    s_add_u32 m0, s75, 24576
    s_cmp_eq_u32 s68, 28
    buffer_load_dwordx4 v3, s[20:23], s101 offen offset:1024 lds
    s_cselect_b32 s68, 0, s68
    s_waitcnt vmcnt(22)
    ds_read_b64_tr_b16 v[160:161], v4 offset:16384
    ds_read_b64_tr_b16 v[162:163], v4 offset:17408
    ds_read_b64_tr_b16 v[164:165], v5 offset:16384
    ds_read_b64_tr_b16 v[166:167], v5 offset:17408
    s_waitcnt lgkmcnt(0)
    s_lshl_b32 s101, s68, 14
    s_add_u32 s101, s101, s79
    s_add_u32 m0, s75, 32768
    s_add_u32 s68, s68, 1
    buffer_load_dwordx4 v2, s[20:23], s101 offen lds
    s_add_u32 m0, s75, 32768
    s_cmp_eq_u32 s68, 28
    buffer_load_dwordx4 v3, s[20:23], s101 offen offset:1024 lds
    s_cselect_b32 s68, 0, s68
    s_waitcnt vmcnt(22)
    ds_read_b64_tr_b16 v[168:169], v4 offset:24576
    ds_read_b64_tr_b16 v[170:171], v4 offset:25600
    ds_read_b64_tr_b16 v[172:173], v5 offset:24576
    ds_read_b64_tr_b16 v[174:175], v5 offset:25600
    s_waitcnt lgkmcnt(0)
    s_lshl_b32 s101, s68, 14
    s_add_u32 s101, s101, s79
    s_add_u32 m0, s75, 40960
    s_add_u32 s68, s68, 1
    buffer_load_dwordx4 v2, s[20:23], s101 offen lds
    s_add_u32 m0, s75, 40960
    s_cmp_eq_u32 s68, 28
    buffer_load_dwordx4 v3, s[20:23], s101 offen offset:1024 lds
    s_cselect_b32 s68, 0, s68
    s_waitcnt vmcnt(22)
    ds_read_b64_tr_b16 v[176:177], v4 offset:32768
    ds_read_b64_tr_b16 v[178:179], v4 offset:33792
    ds_read_b64_tr_b16 v[180:181], v5 offset:32768
    ds_read_b64_tr_b16 v[182:183], v5 offset:33792
    s_waitcnt lgkmcnt(0)
    s_lshl_b32 s101, s68, 14
    s_add_u32 s101, s101, s79
    s_add_u32 m0, s75, 49152
    s_add_u32 s68, s68, 1
    buffer_load_dwordx4 v2, s[20:23], s101 offen lds
    s_add_u32 m0, s75, 49152
    s_cmp_eq_u32 s68, 28
    buffer_load_dwordx4 v3, s[20:23], s101 offen offset:1024 lds
    s_cselect_b32 s68, 0, s68
    s_waitcnt vmcnt(18)
    ds_read_b64_tr_b16 v[184:185], v4 offset:40960
    ds_read_b64_tr_b16 v[186:187], v4 offset:41984
    ds_read_b64_tr_b16 v[188:189], v5 offset:40960
    ds_read_b64_tr_b16 v[190:191], v5 offset:41984
    s_waitcnt lgkmcnt(0)
    s_lshl_b32 s101, s68, 14
    s_add_u32 s101, s101, s79
    s_add_u32 m0, s75, 57344
    s_add_u32 s68, s68, 1
    buffer_load_dwordx4 v2, s[20:23], s101 offen lds
    s_add_u32 m0, s75, 57344
    s_cmp_eq_u32 s68, 28
    buffer_load_dwordx4 v3, s[20:23], s101 offen offset:1024 lds
    s_cselect_b32 s68, 0, s68
    s_lshr_b32 s74, s82, 1
    s_lshl_b32 s74, s74, 11
    s_mul_i32 s76, s70, 7
    s_lshr_b32 s76, s76, 1
    s_lshl_b32 s76, s76, 7
    s_add_u32 s74, s74, s76
    s_and_b32 s76, s82, 1
    s_lshl_b32 s76, s76, 6
    s_add_u32 s74, s74, s76
    v_bfe_u32 v11, v1, 1, 2
    v_lshl_add_u32 v11, v11, 7, s74
    v_and_b32 v13, 1, v1
    v_lshl_add_u32 v11, v13, 5, v11
    buffer_load_dwordx2 v[8:9], v11, s[28:31], 0 offen sc1
    v_and_b32 v13, 31, v1
    s_lshl_b32 s74, s82, 10
    s_add_u32 s74, s74, 65536
    v_lshl_add_u32 v12, v13, 5, s74
    s_lshl_b32 s74, s83, 12
    s_add_u32 s74, s74, 32768
    v_lshl_add_u32 v13, v13, 7, s74
    v_cmp_gt_u32 vcc, 32, v1
    s_nop 1
    v_cndmask_b32 v12, v12, v13, vcc
    s_mov_b64 s[32:33], -1
    s_waitcnt vmcnt(0)
    s_mov_b32 s69, 0
fl_8:
    v_cmp_ne_u64 vcc, s[34:35], v[8:9]
    s_nop 1
    s_cbranch_vccz fld_9
    s_add_u32 s69, s69, 1
    s_cmp_ge_u32 s69, 262144
    s_cbranch_scc1 fld_9
    s_mov_b64 exec, vcc
    buffer_load_dwordx2 v[8:9], v11, s[28:31], 0 offen sc1
    s_waitcnt vmcnt(0)
    s_branch fl_8
fld_9:
    s_mov_b64 exec, -1
    s_add_u32 s4, s66, 2097152
    s_addc_u32 s5, s67, 0
    s_mov_b32 s6, 2097152
    s_mov_b32 s7, 0x00020000
    s_add_u32 s8, s66, 4194304
    s_addc_u32 s9, s67, 0
    s_mov_b32 s10, 32768
    s_mov_b32 s11, 0x00020000
    s_mov_b32 s24, s62
    s_mov_b32 s25, s63
    s_mov_b32 s26, 2097152
    s_mov_b32 s27, 0x00020000
    s_lshl_b32 s3, s77, 10
    s_add_u32 s3, s3, s78
    s_add_u32 s77, s77, 1
    s_cmp_eq_u32 s77, 28
    s_cselect_b32 s77, 0, s77
    buffer_load_dwordx4 v[192:195], v6, s[16:19], s3 offen sc1
    buffer_load_dwordx4 v[196:199], v7, s[16:19], s3 offen sc1
    s_lshl_b32 s3, s77, 10
    s_add_u32 s3, s3, s78
    s_add_u32 s77, s77, 1
    s_cmp_eq_u32 s77, 28
    s_cselect_b32 s77, 0, s77
    buffer_load_dwordx4 v[200:203], v6, s[16:19], s3 offen sc1
    buffer_load_dwordx4 v[204:207], v7, s[16:19], s3 offen sc1
    s_lshl_b32 s3, s77, 10
    s_add_u32 s3, s3, s78
    s_add_u32 s77, s77, 1
    s_cmp_eq_u32 s77, 28
    s_cselect_b32 s77, 0, s77
    buffer_load_dwordx4 v[208:211], v6, s[16:19], s3 offen sc1
    buffer_load_dwordx4 v[212:215], v7, s[16:19], s3 offen sc1
    s_lshl_b32 s3, s77, 10
    s_add_u32 s3, s3, s78
    s_add_u32 s77, s77, 1
    s_cmp_eq_u32 s77, 28
    s_cselect_b32 s77, 0, s77
    buffer_load_dwordx4 v[216:219], v6, s[16:19], s3 offen sc1
    buffer_load_dwordx4 v[220:223], v7, s[16:19], s3 offen sc1
    s_lshl_b32 s3, s77, 10
    s_add_u32 s3, s3, s78
    s_add_u32 s77, s77, 1
    s_cmp_eq_u32 s77, 28
    s_cselect_b32 s77, 0, s77
    buffer_load_dwordx4 v[224:227], v6, s[16:19], s3 offen sc1
    buffer_load_dwordx4 v[228:231], v7, s[16:19], s3 offen sc1
    s_waitcnt vmcnt(8)
    v_mfma_f32_32x32x16_bf16 v[16:31], v[80:83], v[192:195], 0
    s_lshl_b32 s3, s77, 10
    s_add_u32 s3, s3, s78
    s_add_u32 s77, s77, 1
    s_cmp_eq_u32 s77, 28
    s_cselect_b32 s77, 0, s77
    buffer_load_dwordx4 v[232:235], v6, s[16:19], s3 offen sc1
    v_mfma_f32_32x32x16_bf16 v[32:47], v[80:83], v[196:199], 0
    buffer_load_dwordx4 v[236:239], v7, s[16:19], s3 offen sc1
    ds_read_b64_tr_b16 v[80:81], v14 offset:0
    ds_read_b64_tr_b16 v[82:83], v14 offset:1024
    v_mfma_f32_32x32x16_bf16 v[48:63], v[84:87], v[192:195], 0
    v_mfma_f32_32x32x16_bf16 v[64:79], v[84:87], v[196:199], 0
    ds_read_b64_tr_b16 v[84:85], v15 offset:0
    ds_read_b64_tr_b16 v[86:87], v15 offset:1024
    s_waitcnt vmcnt(8)
    v_mfma_f32_32x32x16_bf16 v[16:31], v[88:91], v[200:203], v[16:31]
    s_lshl_b32 s3, s77, 10
    s_add_u32 s3, s3, s78
    s_add_u32 s77, s77, 1
    s_cmp_eq_u32 s77, 28
    s_cselect_b32 s77, 0, s77
    buffer_load_dwordx4 v[192:195], v6, s[16:19], s3 offen sc1
    v_mfma_f32_32x32x16_bf16 v[32:47], v[88:91], v[204:207], v[32:47]
    buffer_load_dwordx4 v[196:199], v7, s[16:19], s3 offen sc1
    ds_read_b64_tr_b16 v[88:89], v14 offset:8192
    ds_read_b64_tr_b16 v[90:91], v14 offset:9216
    v_mfma_f32_32x32x16_bf16 v[48:63], v[92:95], v[200:203], v[48:63]
    v_mfma_f32_32x32x16_bf16 v[64:79], v[92:95], v[204:207], v[64:79]
    ds_read_b64_tr_b16 v[92:93], v15 offset:8192
    ds_read_b64_tr_b16 v[94:95], v15 offset:9216
    s_waitcnt vmcnt(8) lgkmcnt(4)
    v_mfma_f32_32x32x16_bf16 v[16:31], v[96:99], v[208:211], v[16:31]
    s_lshl_b32 s3, s77, 10
    s_add_u32 s3, s3, s78
    s_add_u32 s77, s77, 1
    s_cmp_eq_u32 s77, 28
    s_cselect_b32 s77, 0, s77
    buffer_load_dwordx4 v[200:203], v6, s[16:19], s3 offen sc1
    v_mfma_f32_32x32x16_bf16 v[32:47], v[96:99], v[212:215], v[32:47]
    buffer_load_dwordx4 v[204:207], v7, s[16:19], s3 offen sc1
    ds_read_b64_tr_b16 v[96:97], v4 offset:49152
    ds_read_b64_tr_b16 v[98:99], v4 offset:50176
    v_mfma_f32_32x32x16_bf16 v[48:63], v[100:103], v[208:211], v[48:63]
    s_lshl_b32 s101, s68, 14
    s_add_u32 s101, s101, s79
    s_add_u32 m0, s75, 0
    s_add_u32 s68, s68, 1
    buffer_load_dwordx4 v2, s[20:23], s101 offen lds
    v_mfma_f32_32x32x16_bf16 v[64:79], v[100:103], v[212:215], v[64:79]
    s_add_u32 m0, s75, 0
    s_cmp_eq_u32 s68, 28
    buffer_load_dwordx4 v3, s[20:23], s101 offen offset:1024 lds
    s_cselect_b32 s68, 0, s68
    ds_read_b64_tr_b16 v[100:101], v5 offset:49152
    ds_read_b64_tr_b16 v[102:103], v5 offset:50176
    s_waitcnt vmcnt(10) lgkmcnt(4)
    v_mfma_f32_32x32x16_bf16 v[16:31], v[104:107], v[216:219], v[16:31]
    s_lshl_b32 s3, s77, 10
    s_add_u32 s3, s3, s78
    s_add_u32 s77, s77, 1
    s_cmp_eq_u32 s77, 28
    s_cselect_b32 s77, 0, s77
    buffer_load_dwordx4 v[208:211], v6, s[16:19], s3 offen sc1
    v_mfma_f32_32x32x16_bf16 v[32:47], v[104:107], v[220:223], v[32:47]
    buffer_load_dwordx4 v[212:215], v7, s[16:19], s3 offen sc1
    ds_read_b64_tr_b16 v[104:105], v4 offset:57344
    ds_read_b64_tr_b16 v[106:107], v4 offset:58368
    v_mfma_f32_32x32x16_bf16 v[48:63], v[108:111], v[216:219], v[48:63]
    s_lshl_b32 s101, s68, 14
    s_add_u32 s101, s101, s79
    s_add_u32 m0, s75, 8192
    s_add_u32 s68, s68, 1
    buffer_load_dwordx4 v2, s[20:23], s101 offen lds
    v_mfma_f32_32x32x16_bf16 v[64:79], v[108:111], v[220:223], v[64:79]
    s_add_u32 m0, s75, 8192
    s_cmp_eq_u32 s68, 28
    buffer_load_dwordx4 v3, s[20:23], s101 offen offset:1024 lds
    s_cselect_b32 s68, 0, s68
    ds_read_b64_tr_b16 v[108:109], v5 offset:57344
    ds_read_b64_tr_b16 v[110:111], v5 offset:58368
    s_waitcnt vmcnt(12) lgkmcnt(4)
    v_mfma_f32_32x32x16_bf16 v[16:31], v[112:115], v[224:227], v[16:31]
    s_lshl_b32 s3, s77, 10
    s_add_u32 s3, s3, s78
    s_add_u32 s77, s77, 1
    s_cmp_eq_u32 s77, 28
    s_cselect_b32 s77, 0, s77
    buffer_load_dwordx4 v[216:219], v6, s[16:19], s3 offen sc1
    v_mfma_f32_32x32x16_bf16 v[32:47], v[112:115], v[228:231], v[32:47]
    buffer_load_dwordx4 v[220:223], v7, s[16:19], s3 offen sc1
    ds_read_b64_tr_b16 v[112:113], v4 offset:0
    ds_read_b64_tr_b16 v[114:115], v4 offset:1024
    v_mfma_f32_32x32x16_bf16 v[48:63], v[116:119], v[224:227], v[48:63]
    s_lshl_b32 s101, s68, 14
    s_add_u32 s101, s101, s79
    s_add_u32 m0, s75, 65536
    s_add_u32 s68, s68, 1
    buffer_load_dwordx4 v2, s[20:23], s101 offen lds
    v_mfma_f32_32x32x16_bf16 v[64:79], v[116:119], v[228:231], v[64:79]
    s_add_u32 m0, s75, 65536
    s_cmp_eq_u32 s68, 28
    buffer_load_dwordx4 v3, s[20:23], s101 offen offset:1024 lds
    s_cselect_b32 s68, 0, s68
    ds_read_b64_tr_b16 v[116:117], v5 offset:0
    ds_read_b64_tr_b16 v[118:119], v5 offset:1024
    s_waitcnt vmcnt(14) lgkmcnt(4)
    v_mfma_f32_32x32x16_bf16 v[16:31], v[120:123], v[232:235], v[16:31]
    s_lshl_b32 s3, s77, 10
    s_add_u32 s3, s3, s78
    s_add_u32 s77, s77, 1
    s_cmp_eq_u32 s77, 28
    s_cselect_b32 s77, 0, s77
    buffer_load_dwordx4 v[224:227], v6, s[16:19], s3 offen sc1
    v_mfma_f32_32x32x16_bf16 v[32:47], v[120:123], v[236:239], v[32:47]
    buffer_load_dwordx4 v[228:231], v7, s[16:19], s3 offen sc1
    ds_read_b64_tr_b16 v[120:121], v4 offset:8192
    ds_read_b64_tr_b16 v[122:123], v4 offset:9216
    v_mfma_f32_32x32x16_bf16 v[48:63], v[124:127], v[232:235], v[48:63]
    s_lshl_b32 s101, s68, 14
    s_add_u32 s101, s101, s79
    s_add_u32 m0, s75, 73728
    s_add_u32 s68, s68, 1
    buffer_load_dwordx4 v2, s[20:23], s101 offen lds
    v_mfma_f32_32x32x16_bf16 v[64:79], v[124:127], v[236:239], v[64:79]
    s_add_u32 m0, s75, 73728
    s_cmp_eq_u32 s68, 28
    buffer_load_dwordx4 v3, s[20:23], s101 offen offset:1024 lds
    s_cselect_b32 s68, 0, s68
    ds_read_b64_tr_b16 v[124:125], v5 offset:8192
    ds_read_b64_tr_b16 v[126:127], v5 offset:9216
    s_waitcnt vmcnt(16)
    v_mfma_f32_32x32x16_bf16 v[16:31], v[128:131], v[192:195], v[16:31]
    s_lshl_b32 s3, s77, 10
    s_add_u32 s3, s3, s78
    s_add_u32 s77, s77, 1
    s_cmp_eq_u32 s77, 28
    s_cselect_b32 s77, 0, s77
    buffer_load_dwordx4 v[232:235], v6, s[16:19], s3 offen sc1
    v_mfma_f32_32x32x16_bf16 v[32:47], v[128:131], v[196:199], v[32:47]
    buffer_load_dwordx4 v[236:239], v7, s[16:19], s3 offen sc1
    ds_read_b64_tr_b16 v[128:129], v4 offset:16384
    ds_read_b64_tr_b16 v[130:131], v4 offset:17408
    v_mfma_f32_32x32x16_bf16 v[48:63], v[132:135], v[192:195], v[48:63]
    v_mfma_f32_32x32x16_bf16 v[64:79], v[132:135], v[196:199], v[64:79]
    ds_read_b64_tr_b16 v[132:133], v5 offset:16384
    ds_read_b64_tr_b16 v[134:135], v5 offset:17408
    s_waitcnt vmcnt(16)
    v_mfma_f32_32x32x16_bf16 v[16:31], v[136:139], v[200:203], v[16:31]
    s_lshl_b32 s3, s77, 10
    s_add_u32 s3, s3, s78
    s_add_u32 s77, s77, 1
    s_cmp_eq_u32 s77, 28
    s_cselect_b32 s77, 0, s77
    buffer_load_dwordx4 v[192:195], v6, s[16:19], s3 offen sc1
    v_mfma_f32_32x32x16_bf16 v[32:47], v[136:139], v[204:207], v[32:47]
    buffer_load_dwordx4 v[196:199], v7, s[16:19], s3 offen sc1
    ds_read_b64_tr_b16 v[136:137], v4 offset:24576
    ds_read_b64_tr_b16 v[138:139], v4 offset:25600
    v_mfma_f32_32x32x16_bf16 v[48:63], v[140:143], v[200:203], v[48:63]
    v_mfma_f32_32x32x16_bf16 v[64:79], v[140:143], v[204:207], v[64:79]
    ds_read_b64_tr_b16 v[140:141], v5 offset:24576
    ds_read_b64_tr_b16 v[142:143], v5 offset:25600
    s_waitcnt vmcnt(14)
    v_mfma_f32_32x32x16_bf16 v[16:31], v[144:147], v[208:211], v[16:31]
    s_lshl_b32 s3, s77, 10
    s_add_u32 s3, s3, s78
    s_add_u32 s77, s77, 1
    s_cmp_eq_u32 s77, 28
    s_cselect_b32 s77, 0, s77
    buffer_load_dwordx4 v[200:203], v6, s[16:19], s3 offen sc1
    v_mfma_f32_32x32x16_bf16 v[32:47], v[144:147], v[212:215], v[32:47]
    buffer_load_dwordx4 v[204:207], v7, s[16:19], s3 offen sc1
    ds_read_b64_tr_b16 v[144:145], v4 offset:32768
    ds_read_b64_tr_b16 v[146:147], v4 offset:33792
    v_mfma_f32_32x32x16_bf16 v[48:63], v[148:151], v[208:211], v[48:63]
    v_mfma_f32_32x32x16_bf16 v[64:79], v[148:151], v[212:215], v[64:79]
    ds_read_b64_tr_b16 v[148:149], v5 offset:32768
    ds_read_b64_tr_b16 v[150:151], v5 offset:33792
    s_waitcnt vmcnt(12)
    v_mfma_f32_32x32x16_bf16 v[16:31], v[152:155], v[216:219], v[16:31]
    s_lshl_b32 s3, s77, 10
    s_add_u32 s3, s3, s78
    s_add_u32 s77, s77, 1
    s_cmp_eq_u32 s77, 28
    s_cselect_b32 s77, 0, s77
    buffer_load_dwordx4 v[208:211], v6, s[16:19], s3 offen sc1
    v_mfma_f32_32x32x16_bf16 v[32:47], v[152:155], v[220:223], v[32:47]
    buffer_load_dwordx4 v[212:215], v7, s[16:19], s3 offen sc1
    ds_read_b64_tr_b16 v[152:153], v4 offset:40960
    ds_read_b64_tr_b16 v[154:155], v4 offset:41984
    v_mfma_f32_32x32x16_bf16 v[48:63], v[156:159], v[216:219], v[48:63]
    v_mfma_f32_32x32x16_bf16 v[64:79], v[156:159], v[220:223], v[64:79]
    ds_read_b64_tr_b16 v[156:157], v5 offset:40960
    ds_read_b64_tr_b16 v[158:159], v5 offset:41984
    s_waitcnt vmcnt(10)
    v_mfma_f32_32x32x16_bf16 v[16:31], v[160:163], v[224:227], v[16:31]
    s_lshl_b32 s3, s77, 10
    s_add_u32 s3, s3, s78
    s_add_u32 s77, s77, 1
    s_cmp_eq_u32 s77, 28
    s_cselect_b32 s77, 0, s77
    buffer_load_dwordx4 v[216:219], v6, s[16:19], s3 offen sc1
    v_mfma_f32_32x32x16_bf16 v[32:47], v[160:163], v[228:231], v[32:47]
    buffer_load_dwordx4 v[220:223], v7, s[16:19], s3 offen sc1
    ds_read_b64_tr_b16 v[160:161], v14 offset:0
    ds_read_b64_tr_b16 v[162:163], v14 offset:1024
    v_mfma_f32_32x32x16_bf16 v[48:63], v[164:167], v[224:227], v[48:63]
    v_mfma_f32_32x32x16_bf16 v[64:79], v[164:167], v[228:231], v[64:79]
    ds_read_b64_tr_b16 v[164:165], v15 offset:0
    ds_read_b64_tr_b16 v[166:167], v15 offset:1024
    s_waitcnt vmcnt(8)
    v_mfma_f32_32x32x16_bf16 v[16:31], v[168:171], v[232:235], v[16:31]
    s_lshl_b32 s3, s77, 10
    s_add_u32 s3, s3, s78
    s_add_u32 s77, s77, 1
    s_cmp_eq_u32 s77, 28
    s_cselect_b32 s77, 0, s77
    buffer_load_dwordx4 v[224:227], v6, s[16:19], s3 offen sc1
    v_mfma_f32_32x32x16_bf16 v[32:47], v[168:171], v[236:239], v[32:47]
    buffer_load_dwordx4 v[228:231], v7, s[16:19], s3 offen sc1
    ds_read_b64_tr_b16 v[168:169], v14 offset:8192
    ds_read_b64_tr_b16 v[170:171], v14 offset:9216
    v_mfma_f32_32x32x16_bf16 v[48:63], v[172:175], v[232:235], v[48:63]
    v_mfma_f32_32x32x16_bf16 v[64:79], v[172:175], v[236:239], v[64:79]
    ds_read_b64_tr_b16 v[172:173], v15 offset:8192
    ds_read_b64_tr_b16 v[174:175], v15 offset:9216
    s_waitcnt vmcnt(8)
    v_mfma_f32_32x32x16_bf16 v[16:31], v[176:179], v[192:195], v[16:31]
    s_lshl_b32 s3, s77, 10
    s_add_u32 s3, s3, s78
    s_add_u32 s77, s77, 1
    s_cmp_eq_u32 s77, 28
    s_cselect_b32 s77, 0, s77
    buffer_load_dwordx4 v[232:235], v6, s[16:19], s3 offen sc1
    v_mfma_f32_32x32x16_bf16 v[32:47], v[176:179], v[196:199], v[32:47]
    buffer_load_dwordx4 v[236:239], v7, s[16:19], s3 offen sc1
    ds_read_b64_tr_b16 v[176:177], v4 offset:49152
    ds_read_b64_tr_b16 v[178:179], v4 offset:50176
    v_mfma_f32_32x32x16_bf16 v[48:63], v[180:183], v[192:195], v[48:63]
    v_mfma_f32_32x32x16_bf16 v[64:79], v[180:183], v[196:199], v[64:79]
    ds_read_b64_tr_b16 v[180:181], v5 offset:49152
    ds_read_b64_tr_b16 v[182:183], v5 offset:50176
    s_waitcnt vmcnt(8)
    v_mfma_f32_32x32x16_bf16 v[16:31], v[184:187], v[200:203], v[16:31]
    s_lshl_b32 s3, s77, 10
    s_add_u32 s3, s3, s78
    s_add_u32 s77, s77, 1
    s_cmp_eq_u32 s77, 28
    s_cselect_b32 s77, 0, s77
    buffer_load_dwordx4 v[192:195], v6, s[16:19], s3 offen sc1
    v_mfma_f32_32x32x16_bf16 v[32:47], v[184:187], v[204:207], v[32:47]
    buffer_load_dwordx4 v[196:199], v7, s[16:19], s3 offen sc1
    ds_read_b64_tr_b16 v[184:185], v4 offset:57344
    ds_read_b64_tr_b16 v[186:187], v4 offset:58368
    v_mfma_f32_32x32x16_bf16 v[48:63], v[188:191], v[200:203], v[48:63]
    v_mfma_f32_32x32x16_bf16 v[64:79], v[188:191], v[204:207], v[64:79]
    ds_read_b64_tr_b16 v[188:189], v5 offset:57344
    ds_read_b64_tr_b16 v[190:191], v5 offset:58368
    s_waitcnt vmcnt(8)
    v_mfma_f32_32x32x16_bf16 v[16:31], v[80:83], v[208:211], v[16:31]
    s_lshl_b32 s3, s77, 10
    s_add_u32 s3, s3, s78
    s_add_u32 s77, s77, 1
    s_cmp_eq_u32 s77, 28
    s_cselect_b32 s77, 0, s77
    buffer_load_dwordx4 v[200:203], v6, s[16:19], s3 offen sc1
    v_mfma_f32_32x32x16_bf16 v[32:47], v[80:83], v[212:215], v[32:47]
    buffer_load_dwordx4 v[204:207], v7, s[16:19], s3 offen sc1
    v_mfma_f32_32x32x16_bf16 v[48:63], v[84:87], v[208:211], v[48:63]
    v_mfma_f32_32x32x16_bf16 v[64:79], v[84:87], v[212:215], v[64:79]
    s_waitcnt vmcnt(8) lgkmcnt(0)
    v_mfma_f32_32x32x16_bf16 v[16:31], v[88:91], v[216:219], v[16:31]
    s_lshl_b32 s3, s77, 10
    s_add_u32 s3, s3, s78
    s_add_u32 s77, s77, 1
    s_cmp_eq_u32 s77, 28
    s_cselect_b32 s77, 0, s77
    buffer_load_dwordx4 v[208:211], v6, s[16:19], s3 offen sc1
    v_mfma_f32_32x32x16_bf16 v[32:47], v[88:91], v[220:223], v[32:47]
    buffer_load_dwordx4 v[212:215], v7, s[16:19], s3 offen sc1
    v_mfma_f32_32x32x16_bf16 v[48:63], v[92:95], v[216:219], v[48:63]
    v_mfma_f32_32x32x16_bf16 v[64:79], v[92:95], v[220:223], v[64:79]
    s_waitcnt vmcnt(8)
    v_mfma_f32_32x32x16_bf16 v[16:31], v[96:99], v[224:227], v[16:31]
    s_lshl_b32 s3, s77, 10
    s_add_u32 s3, s3, s78
    s_add_u32 s77, s77, 1
    s_cmp_eq_u32 s77, 28
    s_cselect_b32 s77, 0, s77
    buffer_load_dwordx4 v[216:219], v6, s[16:19], s3 offen sc1
    v_mfma_f32_32x32x16_bf16 v[32:47], v[96:99], v[228:231], v[32:47]
    buffer_load_dwordx4 v[220:223], v7, s[16:19], s3 offen sc1
    v_mfma_f32_32x32x16_bf16 v[48:63], v[100:103], v[224:227], v[48:63]
    v_mfma_f32_32x32x16_bf16 v[64:79], v[100:103], v[228:231], v[64:79]
    s_waitcnt vmcnt(8)
    v_mfma_f32_32x32x16_bf16 v[16:31], v[104:107], v[232:235], v[16:31]
    s_lshl_b32 s3, s77, 10
    s_add_u32 s3, s3, s78
    s_add_u32 s77, s77, 1
    s_cmp_eq_u32 s77, 28
    s_cselect_b32 s77, 0, s77
    buffer_load_dwordx4 v[224:227], v6, s[16:19], s3 offen sc1
    v_mfma_f32_32x32x16_bf16 v[32:47], v[104:107], v[236:239], v[32:47]
    buffer_load_dwordx4 v[228:231], v7, s[16:19], s3 offen sc1
    v_mfma_f32_32x32x16_bf16 v[48:63], v[108:111], v[232:235], v[48:63]
    v_mfma_f32_32x32x16_bf16 v[64:79], v[108:111], v[236:239], v[64:79]
    s_waitcnt vmcnt(8)
    v_mfma_f32_32x32x16_bf16 v[16:31], v[112:115], v[192:195], v[16:31]
    s_lshl_b32 s3, s77, 10
    s_add_u32 s3, s3, s78
    s_add_u32 s77, s77, 1
    s_cmp_eq_u32 s77, 28
    s_cselect_b32 s77, 0, s77
    buffer_load_dwordx4 v[232:235], v6, s[16:19], s3 offen sc1
    v_mfma_f32_32x32x16_bf16 v[32:47], v[112:115], v[196:199], v[32:47]
    buffer_load_dwordx4 v[236:239], v7, s[16:19], s3 offen sc1
    v_mfma_f32_32x32x16_bf16 v[48:63], v[116:119], v[192:195], v[48:63]
    v_mfma_f32_32x32x16_bf16 v[64:79], v[116:119], v[196:199], v[64:79]
    s_waitcnt vmcnt(8)
    v_mfma_f32_32x32x16_bf16 v[16:31], v[120:123], v[200:203], v[16:31]
    s_lshl_b32 s3, s77, 10
    s_add_u32 s3, s3, s78
    s_add_u32 s77, s77, 1
    s_cmp_eq_u32 s77, 28
    s_cselect_b32 s77, 0, s77
    buffer_load_dwordx4 v[192:195], v6, s[16:19], s3 offen sc1
    v_mfma_f32_32x32x16_bf16 v[32:47], v[120:123], v[204:207], v[32:47]
    buffer_load_dwordx4 v[196:199], v7, s[16:19], s3 offen sc1
    v_mfma_f32_32x32x16_bf16 v[48:63], v[124:127], v[200:203], v[48:63]
    v_mfma_f32_32x32x16_bf16 v[64:79], v[124:127], v[204:207], v[64:79]
    s_waitcnt vmcnt(8)
    v_mfma_f32_32x32x16_bf16 v[16:31], v[128:131], v[208:211], v[16:31]
    s_lshl_b32 s3, s77, 10
    s_add_u32 s3, s3, s78
    s_add_u32 s77, s77, 1
    s_cmp_eq_u32 s77, 28
    s_cselect_b32 s77, 0, s77
    buffer_load_dwordx4 v[200:203], v6, s[16:19], s3 offen sc1
    v_mfma_f32_32x32x16_bf16 v[32:47], v[128:131], v[212:215], v[32:47]
    buffer_load_dwordx4 v[204:207], v7, s[16:19], s3 offen sc1
    v_mfma_f32_32x32x16_bf16 v[48:63], v[132:135], v[208:211], v[48:63]
    v_mfma_f32_32x32x16_bf16 v[64:79], v[132:135], v[212:215], v[64:79]
    s_waitcnt vmcnt(8)
    v_mfma_f32_32x32x16_bf16 v[16:31], v[136:139], v[216:219], v[16:31]
    s_lshl_b32 s3, s77, 10
    s_add_u32 s3, s3, s78
    s_add_u32 s77, s77, 1
    s_cmp_eq_u32 s77, 28
    s_cselect_b32 s77, 0, s77
    buffer_load_dwordx4 v[208:211], v6, s[16:19], s3 offen sc1
    v_mfma_f32_32x32x16_bf16 v[32:47], v[136:139], v[220:223], v[32:47]
    buffer_load_dwordx4 v[212:215], v7, s[16:19], s3 offen sc1
    v_mfma_f32_32x32x16_bf16 v[48:63], v[140:143], v[216:219], v[48:63]
    v_mfma_f32_32x32x16_bf16 v[64:79], v[140:143], v[220:223], v[64:79]
    s_waitcnt vmcnt(8)
    v_mfma_f32_32x32x16_bf16 v[16:31], v[144:147], v[224:227], v[16:31]
    s_lshl_b32 s3, s77, 10
    s_add_u32 s3, s3, s78
    s_add_u32 s77, s77, 1
    s_cmp_eq_u32 s77, 28
    s_cselect_b32 s77, 0, s77
    buffer_load_dwordx4 v[216:219], v6, s[16:19], s3 offen sc1
    v_mfma_f32_32x32x16_bf16 v[32:47], v[144:147], v[228:231], v[32:47]
    buffer_load_dwordx4 v[220:223], v7, s[16:19], s3 offen sc1
    v_mfma_f32_32x32x16_bf16 v[48:63], v[148:151], v[224:227], v[48:63]
    v_mfma_f32_32x32x16_bf16 v[64:79], v[148:151], v[228:231], v[64:79]
    s_waitcnt vmcnt(8)
    v_mfma_f32_32x32x16_bf16 v[16:31], v[152:155], v[232:235], v[16:31]
    s_cmp_eq_u32 s70, 0
    s_cselect_b64 exec, -1, 1
    buffer_load_dwordx2 v[8:9], v12, s[28:31], 0 offen sc1
    s_mov_b64 exec, -1
    v_and_b32 v11, 31, v1
    v_lshrrev_b32 v14, 5, v1
    v_and_b32 v13, 24, v11
    v_add_lshl_u32 v15, v13, v11, 3
    s_lshl_b32 s79, s73, 4
    v_lshrrev_b32 v13, 2, v1
    v_lshlrev_b32 v13, 12, v13
    v_and_b32 v80, 3, v1
    v_lshl_add_u32 v13, v80, 4, v13
    s_lshl_b32 s74, s72, 12
    s_lshl_b32 s76, s73, 1
    s_add_u32 s71, s74, s76
    v_mfma_f32_32x32x16_bf16 v[32:47], v[152:155], v[236:239], v[32:47]
    v_mfma_f32_32x32x16_bf16 v[48:63], v[156:159], v[232:235], v[48:63]
    v_mfma_f32_32x32x16_bf16 v[64:79], v[156:159], v[236:239], v[64:79]
    s_waitcnt vmcnt(7)
    v_mfma_f32_32x32x16_bf16 v[16:31], v[160:163], v[192:195], v[16:31]
    v_mfma_f32_32x32x16_bf16 v[32:47], v[160:163], v[196:199], v[32:47]
    v_mfma_f32_32x32x16_bf16 v[48:63], v[164:167], v[192:195], v[48:63]
    v_mfma_f32_32x32x16_bf16 v[64:79], v[164:167], v[196:199], v[64:79]
    s_waitcnt vmcnt(5)
    v_mfma_f32_32x32x16_bf16 v[16:31], v[168:171], v[200:203], v[16:31]
    v_mfma_f32_32x32x16_bf16 v[32:47], v[168:171], v[204:207], v[32:47]
    v_mfma_f32_32x32x16_bf16 v[48:63], v[172:175], v[200:203], v[48:63]
    v_mfma_f32_32x32x16_bf16 v[64:79], v[172:175], v[204:207], v[64:79]
    s_waitcnt vmcnt(3)
    v_mfma_f32_32x32x16_bf16 v[16:31], v[176:179], v[208:211], v[16:31]
    v_mfma_f32_32x32x16_bf16 v[32:47], v[176:179], v[212:215], v[32:47]
    v_mfma_f32_32x32x16_bf16 v[48:63], v[180:183], v[208:211], v[48:63]
    v_mfma_f32_32x32x16_bf16 v[64:79], v[180:183], v[212:215], v[64:79]
    s_waitcnt vmcnt(1)
    v_mfma_f32_32x32x16_bf16 v[16:31], v[184:187], v[216:219], v[16:31]
    v_mfma_f32_32x32x16_bf16 v[32:47], v[184:187], v[220:223], v[32:47]
    v_mfma_f32_32x32x16_bf16 v[48:63], v[188:191], v[216:219], v[48:63]
    v_mfma_f32_32x32x16_bf16 v[64:79], v[188:191], v[220:223], v[64:79]
    v_lshl_add_u32 v192, v1, 4, s75
    v_xor_b32 v193, 2048, v192
    v_xor_b32 v194, 4096, v192
    v_xor_b32 v195, 6144, v192
    s_nop 5
    ds_write_b128 v192, v[32:35] offset:0
    ds_write_b128 v192, v[36:39] offset:1024
    ds_write_b128 v192, v[40:43] offset:8192
    ds_write_b128 v192, v[44:47] offset:9216
    ds_write_b128 v192, v[48:51] offset:16384
    ds_write_b128 v192, v[52:55] offset:17408
    ds_write_b128 v192, v[56:59] offset:24576
    ds_write_b128 v192, v[60:63] offset:25600
    ds_write_b128 v192, v[64:67] offset:32768
    ds_write_b128 v192, v[68:71] offset:33792
    ds_write_b128 v192, v[72:75] offset:40960
    ds_write_b128 v192, v[76:79] offset:41984
    v_lshlrev_b32 v112, 16, v240
    v_and_b32 v113, 0xffff0000, v240
    v_lshlrev_b32 v114, 16, v241
    v_and_b32 v115, 0xffff0000, v241
    v_lshlrev_b32 v116, 16, v242
    v_and_b32 v117, 0xffff0000, v242
    v_lshlrev_b32 v118, 16, v243
    v_and_b32 v119, 0xffff0000, v243
    v_lshlrev_b32 v120, 16, v244
    v_and_b32 v121, 0xffff0000, v244
    v_lshlrev_b32 v122, 16, v245
    v_and_b32 v123, 0xffff0000, v245
    v_lshlrev_b32 v124, 16, v246
    v_and_b32 v125, 0xffff0000, v246
    v_lshlrev_b32 v126, 16, v247
    v_and_b32 v127, 0xffff0000, v247
    v_pk_add_f32 v[16:17], v[16:17], v[112:113]
    v_pk_add_f32 v[18:19], v[18:19], v[114:115]
    v_pk_add_f32 v[20:21], v[20:21], v[116:117]
    v_pk_add_f32 v[22:23], v[22:23], v[118:119]
    v_pk_add_f32 v[24:25], v[24:25], v[120:121]
    v_pk_add_f32 v[26:27], v[26:27], v[122:123]
    v_pk_add_f32 v[28:29], v[28:29], v[124:125]
    v_pk_add_f32 v[30:31], v[30:31], v[126:127]
    v_bfe_u32 v198, v1, 2, 2
    v_lshl_add_u32 v198, v14, 2, v198
    v_lshl_add_u32 v198, v198, 6, s75
    v_bfe_u32 v199, v1, 4, 1
    v_lshl_add_u32 v198, v199, 5, v198
    v_and_b32 v199, 3, v1
    v_lshl_add_u32 v198, v199, 3, v198
    s_cmp_lg_u32 s70, 0
    s_cbranch_scc1 early_10
    s_waitcnt vmcnt(0)
    s_mov_b32 s69, 0
fl_11:
    v_cmp_ne_u64 vcc, s[34:35], v[8:9]
    s_nop 1
    s_cbranch_vccz fld_12
    s_add_u32 s69, s69, 1
    s_cmp_ge_u32 s69, 262144
    s_cbranch_scc1 fld_12
    s_mov_b64 exec, vcc
    buffer_load_dwordx2 v[8:9], v12, s[28:31], 0 offen sc1
    s_waitcnt vmcnt(0)
    s_branch fl_11
fld_12:
    s_mov_b64 exec, -1
early_10:
    s_waitcnt lgkmcnt(0)
    s_barrier
    buffer_load_dwordx2 v[248:249], v15, s[8:11], s79 offen sc1
    s_add_u32 m0, s75, 49152
    s_add_u32 s76, s71, 0
    buffer_load_dwordx4 v13, s[4:7], s76 offen sc1 lds
    s_add_u32 m0, s75, 50176
    s_add_u32 s76, s71, 65536
    buffer_load_dwordx4 v13, s[4:7], s76 offen sc1 lds
early_13:
    ds_read_b128 v[32:35], v193 offset:0
    ds_read_b128 v[36:39], v193 offset:1024
    ds_read_b128 v[40:43], v193 offset:8192
    ds_read_b128 v[44:47], v193 offset:9216
    ds_read_b128 v[48:51], v194 offset:16384
    ds_read_b128 v[52:55], v194 offset:17408
    ds_read_b128 v[56:59], v194 offset:24576
    ds_read_b128 v[60:63], v194 offset:25600
    ds_read_b128 v[64:67], v195 offset:32768
    ds_read_b128 v[68:71], v195 offset:33792
    ds_read_b128 v[72:75], v195 offset:40960
    ds_read_b128 v[76:79], v195 offset:41984
    v_lshlrev_b32 v15, 10, v11
    v_lshl_add_u32 v15, v14, 4, v15
    s_lshl_b32 s74, s73, 10
    s_lshl_b32 s76, s72, 1
    s_add_u32 s74, s74, s76
    s_waitcnt lgkmcnt(8)
    v_pk_add_f32 v[16:17], v[16:17], v[32:33]
    v_pk_add_f32 v[18:19], v[18:19], v[34:35]
    v_pk_add_f32 v[20:21], v[20:21], v[36:37]
    v_pk_add_f32 v[22:23], v[22:23], v[38:39]
    v_pk_add_f32 v[24:25], v[24:25], v[40:41]
    v_pk_add_f32 v[26:27], v[26:27], v[42:43]
    v_pk_add_f32 v[28:29], v[28:29], v[44:45]
    v_pk_add_f32 v[30:31], v[30:31], v[46:47]
    s_waitcnt lgkmcnt(4)
    v_pk_add_f32 v[16:17], v[16:17], v[48:49]
    v_pk_add_f32 v[18:19], v[18:19], v[50:51]
    v_pk_add_f32 v[20:21], v[20:21], v[52:53]
    v_pk_add_f32 v[22:23], v[22:23], v[54:55]
    v_pk_add_f32 v[24:25], v[24:25], v[56:57]
    v_pk_add_f32 v[26:27], v[26:27], v[58:59]
    v_pk_add_f32 v[28:29], v[28:29], v[60:61]
    v_pk_add_f32 v[30:31], v[30:31], v[62:63]
    s_waitcnt lgkmcnt(0)
    v_pk_add_f32 v[16:17], v[16:17], v[64:65]
    v_pk_add_f32 v[18:19], v[18:19], v[66:67]
    v_pk_add_f32 v[20:21], v[20:21], v[68:69]
    v_pk_add_f32 v[22:23], v[22:23], v[70:71]
    v_pk_add_f32 v[24:25], v[24:25], v[72:73]
    v_pk_add_f32 v[26:27], v[26:27], v[74:75]
    v_pk_add_f32 v[28:29], v[28:29], v[76:77]
    v_pk_add_f32 v[30:31], v[30:31], v[78:79]
    s_waitcnt vmcnt(0)
    ds_read_b64_tr_b16 v[96:97], v198 offset:49152
    ds_read_b64_tr_b16 v[98:99], v198 offset:49664
    ds_read_b64_tr_b16 v[100:101], v198 offset:50176
    ds_read_b64_tr_b16 v[102:103], v198 offset:50688
    s_waitcnt lgkmcnt(0)
    v_mov_b32 v196, v249
    v_mov_b32 v197, v249
    v_mov_b32 v249, v248
    v_lshlrev_b32 v80, 16, v96
    v_and_b32 v81, 0xffff0000, v96
    v_lshlrev_b32 v82, 16, v97
    v_and_b32 v83, 0xffff0000, v97
    v_lshlrev_b32 v84, 16, v98
    v_and_b32 v85, 0xffff0000, v98
    v_lshlrev_b32 v86, 16, v99
    v_and_b32 v87, 0xffff0000, v99
    v_lshlrev_b32 v88, 16, v100
    v_and_b32 v89, 0xffff0000, v100
    v_lshlrev_b32 v90, 16, v101
    v_and_b32 v91, 0xffff0000, v101
    v_lshlrev_b32 v92, 16, v102
    v_and_b32 v93, 0xffff0000, v102
    v_lshlrev_b32 v94, 16, v103
    v_and_b32 v95, 0xffff0000, v103
    v_pk_mul_f32 v[80:81], v[80:81], v[248:249]
    v_pk_mul_f32 v[82:83], v[82:83], v[248:249]
    v_pk_mul_f32 v[84:85], v[84:85], v[248:249]
    v_pk_mul_f32 v[86:87], v[86:87], v[248:249]
    v_pk_mul_f32 v[88:89], v[88:89], v[248:249]
    v_pk_mul_f32 v[90:91], v[90:91], v[248:249]
    v_pk_mul_f32 v[92:93], v[92:93], v[248:249]
    v_pk_mul_f32 v[94:95], v[94:95], v[248:249]
    v_pk_fma_f32 v[16:17], v[16:17], v[196:197], v[80:81]
    v_pk_fma_f32 v[18:19], v[18:19], v[196:197], v[82:83]
    v_pk_fma_f32 v[20:21], v[20:21], v[196:197], v[84:85]
    v_pk_fma_f32 v[22:23], v[22:23], v[196:197], v[86:87]
    v_pk_fma_f32 v[24:25], v[24:25], v[196:197], v[88:89]
    v_pk_fma_f32 v[26:27], v[26:27], v[196:197], v[90:91]
    v_pk_fma_f32 v[28:29], v[28:29], v[196:197], v[92:93]
    v_pk_fma_f32 v[30:31], v[30:31], v[196:197], v[94:95]
    v_cvt_pk_bf16_f32 v112, v16, v17
    v_cvt_pk_bf16_f32 v113, v18, v19
    v_cvt_pk_bf16_f32 v114, v20, v21
    v_cvt_pk_bf16_f32 v115, v22, v23
    v_cvt_pk_bf16_f32 v116, v24, v25
    v_cvt_pk_bf16_f32 v117, v26, v27
    v_cvt_pk_bf16_f32 v118, v28, v29
    v_cvt_pk_bf16_f32 v119, v30, v31
    s_nop 1
    v_permlane32_swap_b32 v112, v114
    v_permlane32_swap_b32 v113, v115
    v_permlane32_swap_b32 v116, v118
    v_permlane32_swap_b32 v117, v119
    s_nop 1
    buffer_store_dwordx4 v[112:115], v15, s[24:27], s74 offen offset:0 nt
    buffer_store_dwordx4 v[116:119], v15, s[24:27], s74 offen offset:32 nt
    s_endpgm
k_ssm:
    v_lshlrev_b32 v72, 3, v0
    v_sub_u32 v72, 2040, v72
    v_cvt_f32_u32 v72, v72
    v_mov_b32 v73, v72
    v_add_f32 v74, 1.0, v73
    v_cvt_pk_bf16_f32 v75, v73, v74
    v_lshlrev_b32 v73, 16, v75
    v_and_b32 v74, 0xffff0000, v75
    v_cvt_u32_f32 v73, v73
    v_cvt_u32_f32 v74, v74
    v_lshlrev_b32 v56, 1, v73
    v_lshlrev_b32 v57, 1, v74
    v_add_f32 v73, 2.0, v72
    v_add_f32 v74, 1.0, v73
    v_cvt_pk_bf16_f32 v75, v73, v74
    v_lshlrev_b32 v73, 16, v75
    v_and_b32 v74, 0xffff0000, v75
    v_cvt_u32_f32 v73, v73
    v_cvt_u32_f32 v74, v74
    v_lshlrev_b32 v58, 1, v73
    v_lshlrev_b32 v59, 1, v74
    v_add_f32 v73, 4.0, v72
    v_add_f32 v74, 1.0, v73
    v_cvt_pk_bf16_f32 v75, v73, v74
    v_lshlrev_b32 v73, 16, v75
    v_and_b32 v74, 0xffff0000, v75
    v_cvt_u32_f32 v73, v73
    v_cvt_u32_f32 v74, v74
    v_lshlrev_b32 v60, 1, v73
    v_lshlrev_b32 v61, 1, v74
    v_add_f32 v73, 0x40c00000, v72
    v_add_f32 v74, 1.0, v73
    v_cvt_pk_bf16_f32 v75, v73, v74
    v_lshlrev_b32 v73, 16, v75
    v_and_b32 v74, 0xffff0000, v75
    v_cvt_u32_f32 v73, v73
    v_cvt_u32_f32 v74, v74
    v_lshlrev_b32 v62, 1, v73
    v_lshlrev_b32 v63, 1, v74
    v_and_b32 v72, 15, v1
    v_lshlrev_b32 v72, 3, v72
    v_lshrrev_b32 v73, 4, v1
    s_lshr_b32 s72, s70, 1
    s_mul_i32 s72, s72, 4128
    s_add_u32 s72, s72, 60416
    v_lshl_add_u32 v74, v73, 9, v72
    v_add_u32 v74, 1024, v74
    v_min_u32 v74, 2049, v74
    v_lshl_add_u32 v68, v74, 1, s72
    v_lshl_add_u32 v74, v73, 9, v72
    v_add_u32 v74, 1152, v74
    v_min_u32 v74, 2049, v74
    v_lshl_add_u32 v69, v74, 1, s72
    v_lshl_add_u32 v74, v73, 9, v72
    v_add_u32 v74, 1280, v74
    v_min_u32 v74, 2049, v74
    v_lshl_add_u32 v70, v74, 1, s72
    v_lshl_add_u32 v74, v73, 9, v72
    v_add_u32 v74, 1408, v74
    v_min_u32 v74, 2049, v74
    v_lshl_add_u32 v71, v74, 1, s72
    v_lshrrev_b32 v74, 1, v73
    v_lshlrev_b32 v74, 7, v74
    v_and_b32 v75, 1, v73
    v_lshl_add_u32 v74, v75, 2, v74
    v_lshlrev_b32 v75, 7, v73
    v_add_u32 v75, 256, v75
    v_lshlrev_b32 v76, 8, v73
    v_cmp_gt_u32 vcc, 2, v73
    v_mov_b32 v77, 4
    v_mov_b32 v78, 128
    v_cndmask_b32 v75, v76, v75, vcc
    v_cndmask_b32 v76, v77, 2, vcc
    v_cndmask_b32 v77, v78, v77, vcc
    s_and_b32 s73, s70, 1
    s_cmp_eq_u32 s73, 0
    s_cselect_b64 vcc, -1, 0
    s_nop 1
    v_cndmask_b32 v74, v75, v74, vcc
    v_cndmask_b32 v76, v76, 1, vcc
    v_cndmask_b32 v77, v77, 2, vcc
    v_add_u32 v74, v74, v72
    v_lshl_add_u32 v64, v74, 1, s72
    v_lshl_add_u32 v65, v76, 1, v64
    v_lshl_add_u32 v66, v77, 1, v64
    v_lshl_add_u32 v67, v76, 1, v66
    v_mov_b32 v76, 0
    v_mov_b32 v77, 0
    v_mov_b32 v78, 0
    v_mov_b32 v79, 0
    v_lshlrev_b32 v72, 4, v0
    v_cmp_gt_u32 vcc, 30, v0
    s_and_saveexec_b64 s[74:75], vcc
    v_add_u32 v72, 68672, v72
    ds_write_b128 v72, v[76:79]
    ds_write_b128 v72, v[76:79] offset:4576
    s_mov_b64 exec, s[74:75]
    s_mov_b32 s12, s64
    s_mov_b32 s13, s65
    s_mov_b32 s14, 256
    s_mov_b32 s15, 0x00020000
    s_add_u32 s16, s66, 6291456
    s_addc_u32 s17, s67, 0
    s_mov_b32 s18, 131072
    s_mov_b32 s19, 0x00020000
    s_mov_b32 s74, 1069066811
    s_mov_b32 s75, 849703008
    s_mov_b32 s76, 1060205080
    s_mov_b32 s77, 1042479491
    s_lshr_b32 s72, s70, 1
    s_mul_i32 s72, s72, 30096
    v_and_b32 v7, 127, v0
    v_lshl_add_u32 v7, v7, 2, s72
    s_waitcnt vmcnt(0)
    v_lshlrev_b32 v40, 16, v40
    v_lshlrev_b32 v41, 16, v41
    v_lshlrev_b32 v42, 16, v42
    v_lshlrev_b32 v43, 16, v43
    v_lshlrev_b32 v44, 16, v44
    v_lshlrev_b32 v45, 16, v45
    v_mul_f32 v82, s74, v44
    v_fma_f32 v83, v44, s74, -v82
    v_fma_f32 v83, v44, s75, v83
    v_exp_f32 v80, v82
    v_mul_f32 v83, s76, v83
    v_fma_f32 v80, v80, v83, v80
    v_mul_f32 v84, s74, v40
    v_fma_f32 v85, v40, s74, -v84
    v_fma_f32 v85, v40, s75, v85
    v_exp_f32 v81, v84
    v_mul_f32 v85, s76, v85
    v_fma_f32 v81, v81, v85, v81
    v_cvt_pk_bf16_f32 v82, v80, v81
    v_lshlrev_b32 v80, 16, v82
    v_and_b32 v81, 0xffff0000, v82
    v_mul_f32 v81, v81, v80
    v_mul_f32 v41, v41, v80
    v_add_f32 v80, v80, v80
    v_mul_f32 v81, s74, v81
    v_mul_f32 v41, s77, v41
    v_mul_f32 v84, v42, v80
    v_mul_f32 v85, v43, v80
    v_mul_f32 v98, 1.0, v81
    v_mul_f32 v99, 1.0, v41
    v_exp_f32 v98, -v98
    v_fract_f32 v99, v99
    v_cos_f32 v88, v99
    v_sin_f32 v89, v99
    s_nop 0
    v_mul_f32 v88, v88, v98
    v_mul_f32 v89, v89, v98
    v_mul_f32 v98, 0x41000000, v81
    v_mul_f32 v99, 0x41000000, v41
    v_exp_f32 v98, -v98
    v_fract_f32 v99, v99
    v_cos_f32 v90, v99
    v_sin_f32 v91, v99
    s_nop 0
    v_mul_f32 v90, v90, v98
    v_mul_f32 v91, -v91, v98
    v_mul_f32 v98, 0x43000000, v81
    v_mul_f32 v99, 0x43000000, v41
    v_exp_f32 v98, -v98
    v_fract_f32 v99, v99
    v_cos_f32 v92, v99
    v_sin_f32 v93, v99
    s_nop 0
    v_mul_f32 v92, v92, v98
    v_mul_f32 v93, v93, v98
    v_mov_b32 v116, 0x3f80
    ds_write_b32 v7, v116 offset:21648
    v_mul_f32 v100, v89, v89
    v_mul_f32 v101, v89, v88
    v_fma_f32 v95, v88, v89, v101
    v_fma_f32 v94, v88, v88, -v100
    v_mul_f32 v104, v85, v93
    v_mul_f32 v105, v85, v92
    v_fma_f32 v119, v84, v93, v105
    v_fma_f32 v118, v84, v92, -v104
    v_mul_f32 v102, v95, v95
    v_mul_f32 v103, v95, v94
    v_fma_f32 v97, v94, v95, v103
    v_fma_f32 v96, v94, v94, -v102
    v_cvt_pk_bf16_f32 v108, v84, v85
    v_cvt_pk_bf16_f32 v111, v118, v119
    ds_write_b32 v7, v111 offset:4224
    ds_write_b32 v7, v108 offset:0
    v_mul_f32 v106, v119, v89
    v_mul_f32 v100, v85, v89
    v_mul_f32 v107, v119, v88
    v_fma_f32 v121, v118, v89, v107
    v_mul_f32 v101, v85, v88
    v_fma_f32 v120, v118, v88, -v106
    v_fma_f32 v115, v84, v89, v101
    v_cvt_pk_bf16_f32 v112, v120, v121
    ds_write_b32 v7, v112 offset:4752
    v_fma_f32 v114, v84, v88, -v100
    v_mul_f32 v104, v121, v89
    v_cvt_pk_bf16_f32 v109, v114, v115
    v_mul_f32 v105, v121, v88
    v_fma_f32 v121, v120, v89, v105
    ds_write_b32 v7, v109 offset:528
    v_fma_f32 v120, v120, v88, -v104
    v_mul_f32 v102, v115, v89
    v_cvt_pk_bf16_f32 v113, v120, v121
    ds_write_b32 v7, v113 offset:5280
    v_mul_f32 v103, v115, v88
    v_mul_f32 v106, v121, v89
    v_fma_f32 v115, v114, v89, v103
    v_mul_f32 v107, v121, v88
    v_fma_f32 v121, v120, v89, v107
    v_fma_f32 v114, v114, v88, -v102
    v_fma_f32 v120, v120, v88, -v106
    v_cvt_pk_bf16_f32 v110, v114, v115
    v_cvt_pk_bf16_f32 v111, v120, v121
    ds_write_b32 v7, v111 offset:5808
    ds_write_b32 v7, v110 offset:1056
    v_mul_f32 v104, v121, v89
    v_mul_f32 v100, v115, v89
    v_mul_f32 v105, v121, v88
    v_fma_f32 v121, v120, v89, v105
    v_mul_f32 v101, v115, v88
    v_fma_f32 v120, v120, v88, -v104
    v_fma_f32 v115, v114, v89, v101
    v_cvt_pk_bf16_f32 v112, v120, v121
    ds_write_b32 v7, v112 offset:6336
    v_fma_f32 v114, v114, v88, -v100
    v_mul_f32 v106, v121, v89
    v_cvt_pk_bf16_f32 v108, v114, v115
    v_mul_f32 v107, v121, v88
    v_fma_f32 v121, v120, v89, v107
    ds_write_b32 v7, v108 offset:1584
    v_fma_f32 v120, v120, v88, -v106
    v_mul_f32 v102, v115, v89
    v_cvt_pk_bf16_f32 v113, v120, v121
    ds_write_b32 v7, v113 offset:6864
    v_mul_f32 v103, v115, v88
    v_mul_f32 v104, v121, v89
    v_fma_f32 v115, v114, v89, v103
    v_mul_f32 v105, v121, v88
    v_fma_f32 v121, v120, v89, v105
    v_fma_f32 v114, v114, v88, -v102
    v_fma_f32 v120, v120, v88, -v104
    v_cvt_pk_bf16_f32 v109, v114, v115
    v_cvt_pk_bf16_f32 v111, v120, v121
    ds_write_b32 v7, v111 offset:7392
    ds_write_b32 v7, v109 offset:2112
    v_mul_f32 v106, v121, v89
    v_mul_f32 v100, v115, v89
    v_mul_f32 v107, v121, v88
    v_fma_f32 v121, v120, v89, v107
    v_mul_f32 v101, v115, v88
    v_fma_f32 v120, v120, v88, -v106
    v_fma_f32 v115, v114, v89, v101
    v_cvt_pk_bf16_f32 v112, v120, v121
    ds_write_b32 v7, v112 offset:7920
    v_fma_f32 v114, v114, v88, -v100
    v_mul_f32 v104, v119, v93
    v_cvt_pk_bf16_f32 v110, v114, v115
    v_mul_f32 v105, v119, v92
    v_fma_f32 v119, v118, v93, v105
    ds_write_b32 v7, v110 offset:2640
    v_fma_f32 v118, v118, v92, -v104
    v_mul_f32 v102, v115, v89
    v_cvt_pk_bf16_f32 v113, v118, v119
    ds_write_b32 v7, v113 offset:8448
    v_mul_f32 v103, v115, v88
    v_mul_f32 v106, v119, v95
    v_fma_f32 v115, v114, v89, v103
    v_mul_f32 v107, v119, v94
    v_fma_f32 v121, v118, v95, v107
    v_fma_f32 v114, v114, v88, -v102
    v_fma_f32 v120, v118, v94, -v106
    v_cvt_pk_bf16_f32 v108, v114, v115
    v_cvt_pk_bf16_f32 v111, v120, v121
    ds_write_b32 v7, v111 offset:8976
    ds_write_b32 v7, v108 offset:3168
    v_mul_f32 v104, v121, v95
    v_mul_f32 v100, v115, v89
    v_mul_f32 v105, v121, v94
    v_fma_f32 v121, v120, v95, v105
    v_mul_f32 v101, v115, v88
    v_fma_f32 v120, v120, v94, -v104
    v_fma_f32 v115, v114, v89, v101
    v_cvt_pk_bf16_f32 v112, v120, v121
    ds_write_b32 v7, v112 offset:9504
    v_fma_f32 v114, v114, v88, -v100
    v_mul_f32 v106, v121, v95
    v_cvt_pk_bf16_f32 v109, v114, v115
    v_mul_f32 v107, v121, v94
    v_fma_f32 v121, v120, v95, v107
    ds_write_b32 v7, v109 offset:3696
    v_fma_f32 v120, v120, v94, -v106
    v_cvt_pk_bf16_f32 v110, v90, v91
    v_cvt_pk_bf16_f32 v113, v120, v121
    ds_write_b32 v7, v113 offset:10032
    ds_write_b32 v7, v110 offset:22176
    v_mul_f32 v104, v119, v93
    v_mul_f32 v102, v91, v91
    v_mul_f32 v105, v119, v92
    v_fma_f32 v119, v118, v93, v105
    v_mul_f32 v103, v91, v90
    v_fma_f32 v118, v118, v92, -v104
    v_fma_f32 v87, v90, v91, v103
    v_cvt_pk_bf16_f32 v111, v118, v119
    ds_write_b32 v7, v111 offset:10560
    v_fma_f32 v86, v90, v90, -v102
    v_mul_f32 v106, v119, v95
    v_cvt_pk_bf16_f32 v108, v86, v87
    v_mul_f32 v107, v119, v94
    v_fma_f32 v121, v118, v95, v107
    ds_write_b32 v7, v108 offset:22704
    v_fma_f32 v120, v118, v94, -v106
    v_mul_f32 v100, v87, v91
    v_cvt_pk_bf16_f32 v112, v120, v121
    ds_write_b32 v7, v112 offset:11088
    v_mul_f32 v101, v87, v90
    v_mul_f32 v104, v121, v95
    v_fma_f32 v87, v86, v91, v101
    v_mul_f32 v105, v121, v94
    v_fma_f32 v121, v120, v95, v105
    v_fma_f32 v86, v86, v90, -v100
    v_fma_f32 v120, v120, v94, -v104
    v_cvt_pk_bf16_f32 v109, v86, v87
    v_cvt_pk_bf16_f32 v113, v120, v121
    ds_write_b32 v7, v113 offset:11616
    ds_write_b32 v7, v109 offset:23232
    v_mul_f32 v106, v121, v95
    v_mul_f32 v102, v87, v91
    v_mul_f32 v107, v121, v94
    v_fma_f32 v121, v120, v95, v107
    v_mul_f32 v103, v87, v90
    v_fma_f32 v120, v120, v94, -v106
    v_fma_f32 v87, v86, v91, v103
    v_cvt_pk_bf16_f32 v111, v120, v121
    ds_write_b32 v7, v111 offset:12144
    v_fma_f32 v86, v86, v90, -v102
    v_mul_f32 v104, v119, v93
    v_cvt_pk_bf16_f32 v110, v86, v87
    v_mul_f32 v105, v119, v92
    v_fma_f32 v119, v118, v93, v105
    ds_write_b32 v7, v110 offset:23760
    v_fma_f32 v118, v118, v92, -v104
    v_mul_f32 v100, v87, v91
    v_cvt_pk_bf16_f32 v112, v118, v119
    v_mul_f32 v101, v87, v90
    ds_write_b32 v7, v112 offset:12672
    v_mul_f32 v106, v119, v97
    v_fma_f32 v87, v86, v91, v101
    v_mul_f32 v107, v119, v96
    v_fma_f32 v86, v86, v90, -v100
    v_fma_f32 v121, v118, v97, v107
    v_fma_f32 v120, v118, v96, -v106
    v_cvt_pk_bf16_f32 v108, v86, v87
    v_cvt_pk_bf16_f32 v113, v120, v121
    ds_write_b32 v7, v108 offset:24288
    ds_write_b32 v7, v113 offset:13200
    v_mul_f32 v104, v119, v93
    v_mul_f32 v102, v87, v91
    v_mul_f32 v105, v119, v92
    v_mul_f32 v103, v87, v90
    v_fma_f32 v119, v118, v93, v105
    v_fma_f32 v118, v118, v92, -v104
    v_fma_f32 v87, v86, v91, v103
    v_cvt_pk_bf16_f32 v111, v118, v119
    v_fma_f32 v86, v86, v90, -v102
    ds_write_b32 v7, v111 offset:13728
    v_mul_f32 v106, v119, v97
    v_cvt_pk_bf16_f32 v109, v86, v87
    v_mul_f32 v107, v119, v96
    ds_write_b32 v7, v109 offset:24816
    v_fma_f32 v121, v118, v97, v107
    v_fma_f32 v120, v118, v96, -v106
    v_mul_f32 v100, v87, v91
    v_cvt_pk_bf16_f32 v112, v120, v121
    v_mul_f32 v101, v87, v90
    ds_write_b32 v7, v112 offset:14256
    v_mul_f32 v104, v119, v93
    v_fma_f32 v87, v86, v91, v101
    v_mul_f32 v105, v119, v92
    v_fma_f32 v86, v86, v90, -v100
    v_fma_f32 v119, v118, v93, v105
    v_fma_f32 v118, v118, v92, -v104
    v_cvt_pk_bf16_f32 v110, v86, v87
    v_cvt_pk_bf16_f32 v113, v118, v119
    ds_write_b32 v7, v110 offset:25344
    ds_write_b32 v7, v113 offset:14784
    v_mul_f32 v106, v119, v97
    v_mul_f32 v102, v87, v91
    v_mul_f32 v107, v119, v96
    v_mul_f32 v103, v87, v90
    v_fma_f32 v121, v118, v97, v107
    v_fma_f32 v120, v118, v96, -v106
    v_fma_f32 v87, v86, v91, v103
    v_cvt_pk_bf16_f32 v111, v120, v121
    v_fma_f32 v86, v86, v90, -v102
    ds_write_b32 v7, v111 offset:15312
    v_mul_f32 v104, v119, v93
    v_cvt_pk_bf16_f32 v108, v86, v87
    v_mul_f32 v105, v119, v92
    ds_write_b32 v7, v108 offset:25872
    v_fma_f32 v119, v118, v93, v105
    v_fma_f32 v118, v118, v92, -v104
    v_mul_f32 v100, v87, v91
    v_cvt_pk_bf16_f32 v112, v118, v119
    v_mul_f32 v101, v87, v90
    ds_write_b32 v7, v112 offset:15840
    v_mul_f32 v106, v119, v97
    v_fma_f32 v87, v86, v91, v101
    v_mul_f32 v107, v119, v96
    v_fma_f32 v86, v86, v90, -v100
    v_fma_f32 v121, v118, v97, v107
    v_fma_f32 v120, v118, v96, -v106
    v_cvt_pk_bf16_f32 v109, v86, v87
    v_cvt_pk_bf16_f32 v113, v120, v121
    ds_write_b32 v7, v109 offset:26400
    ds_write_b32 v7, v113 offset:16368
    v_mul_f32 v104, v119, v93
    v_mul_f32 v102, v87, v91
    v_mul_f32 v105, v119, v92
    v_mul_f32 v103, v87, v90
    v_fma_f32 v119, v118, v93, v105
    v_fma_f32 v118, v118, v92, -v104
    v_fma_f32 v87, v86, v91, v103
    v_cvt_pk_bf16_f32 v111, v118, v119
    v_fma_f32 v86, v86, v90, -v102
    ds_write_b32 v7, v111 offset:16896
    v_mul_f32 v106, v119, v93
    v_cvt_pk_bf16_f32 v110, v86, v87
    v_mul_f32 v107, v119, v92
    ds_write_b32 v7, v110 offset:26928
    v_fma_f32 v119, v118, v93, v107
    v_fma_f32 v118, v118, v92, -v106
    v_mul_f32 v100, v87, v91
    v_cvt_pk_bf16_f32 v112, v118, v119
    v_mul_f32 v101, v87, v90
    ds_write_b32 v7, v112 offset:17424
    v_mul_f32 v104, v119, v93
    v_fma_f32 v87, v86, v91, v101
    v_mul_f32 v105, v119, v92
    v_fma_f32 v86, v86, v90, -v100
    v_fma_f32 v119, v118, v93, v105
    v_fma_f32 v118, v118, v92, -v104
    v_cvt_pk_bf16_f32 v108, v86, v87
    v_cvt_pk_bf16_f32 v113, v118, v119
    ds_write_b32 v7, v108 offset:27456
    ds_write_b32 v7, v113 offset:17952
    v_mul_f32 v106, v119, v93
    v_mul_f32 v102, v87, v91
    v_mul_f32 v107, v119, v92
    v_mul_f32 v103, v87, v90
    v_fma_f32 v119, v118, v93, v107
    v_fma_f32 v118, v118, v92, -v106
    v_fma_f32 v87, v86, v91, v103
    v_cvt_pk_bf16_f32 v111, v118, v119
    v_fma_f32 v86, v86, v90, -v102
    ds_write_b32 v7, v111 offset:18480
    v_mul_f32 v104, v119, v93
    v_cvt_pk_bf16_f32 v109, v86, v87
    v_mul_f32 v105, v119, v92
    ds_write_b32 v7, v109 offset:27984
    v_fma_f32 v119, v118, v93, v105
    v_fma_f32 v118, v118, v92, -v104
    v_mul_f32 v100, v87, v91
    v_cvt_pk_bf16_f32 v112, v118, v119
    v_mul_f32 v101, v87, v90
    ds_write_b32 v7, v112 offset:19008
    v_mul_f32 v106, v119, v93
    v_fma_f32 v87, v86, v91, v101
    v_mul_f32 v107, v119, v92
    v_fma_f32 v86, v86, v90, -v100
    v_fma_f32 v119, v118, v93, v107
    v_fma_f32 v118, v118, v92, -v106
    v_cvt_pk_bf16_f32 v110, v86, v87
    v_cvt_pk_bf16_f32 v113, v118, v119
    ds_write_b32 v7, v110 offset:28512
    ds_write_b32 v7, v113 offset:19536
    v_mul_f32 v104, v119, v93
    v_mul_f32 v102, v87, v91
    v_mul_f32 v105, v119, v92
    v_mul_f32 v103, v87, v90
    v_fma_f32 v119, v118, v93, v105
    v_fma_f32 v118, v118, v92, -v104
    v_fma_f32 v87, v86, v91, v103
    v_cvt_pk_bf16_f32 v111, v118, v119
    v_fma_f32 v86, v86, v90, -v102
    ds_write_b32 v7, v111 offset:20064
    v_mul_f32 v106, v119, v93
    v_cvt_pk_bf16_f32 v108, v86, v87
    v_mul_f32 v107, v119, v92
    ds_write_b32 v7, v108 offset:29040
    v_fma_f32 v119, v118, v93, v107
    v_fma_f32 v118, v118, v92, -v106
    v_mul_f32 v100, v87, v91
    v_cvt_pk_bf16_f32 v112, v118, v119
    v_mul_f32 v101, v87, v90
    ds_write_b32 v7, v112 offset:20592
    v_mul_f32 v104, v119, v93
    v_fma_f32 v87, v86, v91, v101
    s_setprio 3
    s_mov_b32 s4, s36
    s_mov_b32 s5, s37
    s_mov_b32 s6, 2097152
    s_mov_b32 s7, 0x00020000
    s_mov_b32 s8, s60
    s_mov_b32 s9, s61
    s_mov_b32 s10, 1024
    s_mov_b32 s11, 0x00020000
    v_lshrrev_b32 v2, 3, v1
    v_lshlrev_b32 v2, 10, v2
    v_and_b32 v3, 7, v1
    v_lshl_add_u32 v2, v3, 4, v2
    v_add_u32 v3, 7168, v2
    s_lshl_b32 s72, s81, 16
    s_lshl_b32 s73, s82, 7
    s_add_u32 s72, s72, s73
    s_lshl_b32 s73, s70, 14
    s_add_u32 s72, s72, s73
    s_lshl_b32 s73, s70, 11
    s_add_u32 m0, s73, 60416
    s_nop 0
    buffer_load_dwordx4 v2, s[4:7], s72 offen lds
    buffer_load_dwordx4 v3, s[4:7], s72 offen offset:1024 lds
    v_lshlrev_b32 v4, 5, v0
    s_lshl_b32 s72, s83, 13
    v_and_b32 v5, 0x3ff, v4
    buffer_load_dwordx4 v[8:11], v4, s[4:7], s72 offen
    buffer_load_dwordx4 v[12:15], v4, s[4:7], s72 offen offset:16
    buffer_load_dwordx4 v[16:19], v5, s[8:11], 0 offen
    buffer_load_dwordx4 v[20:23], v5, s[8:11], 0 offen offset:16
    v_mov_b32 v38, 0
    buffer_load_dwordx2 v[46:47], v38, s[12:15], 0 offen sc1
    s_setprio 1
    v_mul_f32 v105, v119, v92
    v_fma_f32 v86, v86, v90, -v100
    v_fma_f32 v119, v118, v93, v105
    v_fma_f32 v118, v118, v92, -v104
    v_cvt_pk_bf16_f32 v109, v86, v87
    v_cvt_pk_bf16_f32 v113, v118, v119
    ds_write_b32 v7, v109 offset:29568
    ds_write_b32 v7, v113 offset:21120
    s_mov_b32 s4, s66
    s_mov_b32 s5, s67
    s_mov_b32 s6, 2097152
    s_mov_b32 s7, 0x00020000
    s_add_u32 s8, s66, 4194304
    s_addc_u32 s9, s67, 0
    s_mov_b32 s10, 32768
    s_mov_b32 s11, 0x00020000
    v_lshrrev_b32 v2, 4, v1
    v_bfe_u32 v3, v1, 2, 2
    v_lshl_add_u32 v3, v2, 3, v3
    v_lshlrev_b32 v3, 7, v3
    v_and_b32 v4, 1, v1
    v_lshl_add_u32 v3, v4, 3, v3
    v_bfe_u32 v4, v1, 1, 1
    v_lshl_add_u32 v3, v4, 12, v3
    s_lshl_b32 s72, s70, 5
    s_add_u32 s72, s72, 60416
    v_add_u32 v3, s72, v3
    v_and_b32 v4, 7, v1
    v_lshlrev_b32 v4, 12, v4
    v_lshl_add_u32 v4, v2, 4, v4
    v_bfe_u32 v5, v1, 3, 1
    v_lshl_add_u32 v4, v5, 6, v4
    s_lshl_b32 s72, s82, 18
    s_lshl_b32 s73, s70, 16
    s_add_u32 s72, s72, s73
    s_lshl_b32 s73, s81, 7
    s_add_u32 s72, s72, s73
    s_waitcnt vmcnt(5)
    s_barrier
    ds_read_b64_tr_b16 v[24:25], v3 offset:0
    ds_read_b64_tr_b16 v[26:27], v3 offset:512
    ds_read_b64_tr_b16 v[28:29], v3 offset:16
    ds_read_b64_tr_b16 v[30:31], v3 offset:528
    s_waitcnt lgkmcnt(0)
    s_setprio 3
    s_add_u32 s73, s72, 0
    buffer_store_dwordx4 v[24:27], v4, s[4:7], s73 offen sc1
    s_add_u32 s73, s72, 32768
    buffer_store_dwordx4 v[28:31], v4, s[4:7], s73 offen sc1
    s_setprio 1
    s_waitcnt vmcnt(3)
    s_mov_b32 s74, 0x3f803f80
    v_mov_b32 v36, 0
    v_lshlrev_b32 v32, 16, v8
    v_and_b32 v33, 0xffff0000, v8
    v_lshlrev_b32 v34, 16, v16
    v_and_b32 v35, 0xffff0000, v16
    v_mul_f32 v32, v32, v34
    v_mul_f32 v33, v33, v35
    v_cvt_pk_bf16_f32 v34, v32, v33
    v_dot2_f32_bf16 v36, v34, s74, v36
    v_lshlrev_b32 v32, 16, v9
    v_and_b32 v33, 0xffff0000, v9
    v_lshlrev_b32 v34, 16, v17
    v_and_b32 v35, 0xffff0000, v17
    v_mul_f32 v32, v32, v34
    v_mul_f32 v33, v33, v35
    v_cvt_pk_bf16_f32 v34, v32, v33
    v_dot2_f32_bf16 v36, v34, s74, v36
    v_lshlrev_b32 v32, 16, v10
    v_and_b32 v33, 0xffff0000, v10
    v_lshlrev_b32 v34, 16, v18
    v_and_b32 v35, 0xffff0000, v18
    v_mul_f32 v32, v32, v34
    v_mul_f32 v33, v33, v35
    v_cvt_pk_bf16_f32 v34, v32, v33
    v_dot2_f32_bf16 v36, v34, s74, v36
    v_lshlrev_b32 v32, 16, v11
    v_and_b32 v33, 0xffff0000, v11
    v_lshlrev_b32 v34, 16, v19
    v_and_b32 v35, 0xffff0000, v19
    v_mul_f32 v32, v32, v34
    v_mul_f32 v33, v33, v35
    v_cvt_pk_bf16_f32 v34, v32, v33
    v_dot2_f32_bf16 v36, v34, s74, v36
    v_lshlrev_b32 v32, 16, v12
    v_and_b32 v33, 0xffff0000, v12
    v_lshlrev_b32 v34, 16, v20
    v_and_b32 v35, 0xffff0000, v20
    v_mul_f32 v32, v32, v34
    v_mul_f32 v33, v33, v35
    v_cvt_pk_bf16_f32 v34, v32, v33
    v_dot2_f32_bf16 v36, v34, s74, v36
    v_lshlrev_b32 v32, 16, v13
    v_and_b32 v33, 0xffff0000, v13
    v_lshlrev_b32 v34, 16, v21
    v_and_b32 v35, 0xffff0000, v21
    v_mul_f32 v32, v32, v34
    v_mul_f32 v33, v33, v35
    v_cvt_pk_bf16_f32 v34, v32, v33
    v_dot2_f32_bf16 v36, v34, s74, v36
    v_lshlrev_b32 v32, 16, v14
    v_and_b32 v33, 0xffff0000, v14
    v_lshlrev_b32 v34, 16, v22
    v_and_b32 v35, 0xffff0000, v22
    v_mul_f32 v32, v32, v34
    v_mul_f32 v33, v33, v35
    v_cvt_pk_bf16_f32 v34, v32, v33
    v_dot2_f32_bf16 v36, v34, s74, v36
    v_lshlrev_b32 v32, 16, v15
    v_and_b32 v33, 0xffff0000, v15
    v_lshlrev_b32 v34, 16, v23
    v_and_b32 v35, 0xffff0000, v23
    v_mul_f32 v32, v32, v34
    v_mul_f32 v33, v33, v35
    v_cvt_pk_bf16_f32 v34, v32, v33
    v_dot2_f32_bf16 v36, v34, s74, v36
    s_nop 1
    s_nop 1
    v_add_f32_dpp v36, v36, v36 quad_perm:[1,0,3,2] row_mask:0xf bank_mask:0xf
    s_nop 1
    v_add_f32_dpp v36, v36, v36 quad_perm:[2,3,0,1] row_mask:0xf bank_mask:0xf
    s_nop 1
    v_add_f32_dpp v36, v36, v36 row_half_mirror row_mask:0xf bank_mask:0xf
    s_nop 1
    v_add_f32_dpp v36, v36, v36 row_mirror row_mask:0xf bank_mask:0xf
    s_nop 1
    v_add_f32_dpp v36, v36, v36 row_bcast:15 row_mask:0xa bank_mask:0xf
    v_cvt_pk_bf16_f32 v36, v36, v36
    v_and_b32 v36, 0xffff0000, v36
    v_sub_f32 v36, 0, v36
    s_mov_b32 s74, 1069066811
    s_mov_b32 s75, 849703008
    s_mov_b32 s76, 1060205080
    v_mul_f32 v33, s74, v36
    v_fma_f32 v34, v36, s74, -v33
    v_fma_f32 v34, v36, s75, v34
    v_exp_f32 v32, v33
    v_mul_f32 v34, s76, v34
    v_fma_f32 v32, v32, v34, v32
    v_add_f32 v32, 1.0, v32
    v_rcp_f32 v33, v32
    s_nop 0
    v_fma_f32 v34, -v32, v33, 1.0
    v_fma_f32 v34, v34, v33, v33
    v_cmp_class_f32 vcc, v34, 3
    s_nop 1
    v_cndmask_b32 v34, v34, v33, vcc
    v_cvt_pk_bf16_f32 v34, v34, v34
    v_and_b32 v34, 0xffff0000, v34
    v_sub_f32 v35, 1.0, v34
    v_cvt_pk_bf16_f32 v35, v35, v35
    v_and_b32 v35, 0xffff0000, v35
    v_lshrrev_b32 v32, 5, v0
    v_lshlrev_b32 v32, 3, v32
    s_lshl_b32 s72, s83, 7
    v_and_b32 v33, 31, v0
    v_cmp_eq_u32 vcc, 16, v33
    s_and_saveexec_b64 s[74:75], vcc
    s_setprio 3
    buffer_store_dwordx2 v[34:35], v32, s[8:11], s72 offen sc1
    s_mov_b64 exec, s[74:75]
    s_setprio 1
    s_lshr_b32 s72, s70, 1
    s_mul_i32 s72, s72, 30096
    s_and_b32 s73, s70, 1
    s_mul_i32 s73, s73, 8448
    v_and_b32 v72, 15, v1
    v_mul_u32_u24 v72, 528, v72
    v_lshrrev_b32 v73, 4, v1
    v_lshl_add_u32 v72, v73, 4, v72
    v_add_u32 v72, s72, v72
    v_add_u32 v73, s73, v72
    s_waitcnt lgkmcnt(0)
    s_barrier
    s_waitcnt vmcnt(0)
    s_setprio 3
    s_mov_b32 s69, 0
tok_15:
    v_readfirstlane_b32 s100, v46
    v_readfirstlane_b32 s101, v47
    s_nop 1
    s_cmp_lg_u32 s100, 0
    s_cbranch_scc1 tokd_16
    s_add_u32 s69, s69, 1
    s_cmp_ge_u32 s69, 262144
    s_cbranch_scc1 tokd_16
    buffer_load_dwordx2 v[46:47], v38, s[12:15], 0 offen sc1
    s_waitcnt vmcnt(0)
    s_branch tok_15
tokd_16:
    s_lshl_b32 s72, s83, 7
    s_lshl_b32 s73, s70, 5
    s_add_u32 s72, s72, s73
    s_add_u32 s72, s72, 65536
    s_mov_b64 exec, 1
    buffer_store_dwordx2 v[46:47], v38, s[16:19], s72 offen sc1
    s_mov_b64 exec, -1
    s_setprio 1
    ds_read_b128 v[88:91], v73 offset:0
    ds_read_b128 v[92:95], v72 offset:16896
    ds_read_b128 v[96:99], v72 offset:21648
    ds_read_b128 v[100:103], v73 offset:64
    ds_read_b128 v[104:107], v72 offset:16960
    ds_read_b128 v[108:111], v72 offset:21712
    ds_read_b128 v[112:115], v73 offset:128
    ds_read_b128 v[116:119], v72 offset:17024
    ds_read_b128 v[120:123], v72 offset:21776
    ds_read_b128 v[124:127], v73 offset:192
    ds_read_b128 v[128:131], v72 offset:17088
    ds_read_b128 v[132:135], v72 offset:21840
    ds_read_b128 v[136:139], v73 offset:256
    ds_read_b128 v[140:143], v72 offset:17152
    ds_read_b128 v[144:147], v72 offset:21904
    ds_read_b128 v[148:151], v73 offset:320
    ds_read_b128 v[152:155], v72 offset:17216
    ds_read_b128 v[156:159], v72 offset:21968
    ds_read_b128 v[160:163], v73 offset:384
    ds_read_b128 v[164:167], v72 offset:17280
    ds_read_b128 v[168:171], v72 offset:22032
    ds_read_b128 v[172:175], v73 offset:448
    ds_read_b128 v[176:179], v72 offset:17344
    ds_read_b128 v[180:183], v72 offset:22096
    s_waitcnt lgkmcnt(15)
    v_mfma_f32_16x16x32_bf16 v[80:83], v[88:91], v[96:99], 0
    v_mfma_f32_16x16x32_bf16 v[84:87], v[92:95], v[96:99], 0
    s_waitcnt lgkmcnt(15)
    v_mfma_f32_16x16x32_bf16 v[80:83], v[100:103], v[108:111], v[80:83]
    v_mfma_f32_16x16x32_bf16 v[84:87], v[104:107], v[108:111], v[84:87]
    s_waitcnt lgkmcnt(15)
    v_mfma_f32_16x16x32_bf16 v[80:83], v[112:115], v[120:123], v[80:83]
    v_mfma_f32_16x16x32_bf16 v[84:87], v[116:119], v[120:123], v[84:87]
    s_waitcnt lgkmcnt(12)
    v_mfma_f32_16x16x32_bf16 v[80:83], v[124:127], v[132:135], v[80:83]
    v_mfma_f32_16x16x32_bf16 v[84:87], v[128:131], v[132:135], v[84:87]
    s_waitcnt lgkmcnt(9)
    v_mfma_f32_16x16x32_bf16 v[80:83], v[136:139], v[144:147], v[80:83]
    v_mfma_f32_16x16x32_bf16 v[84:87], v[140:143], v[144:147], v[84:87]
    s_waitcnt lgkmcnt(6)
    v_mfma_f32_16x16x32_bf16 v[80:83], v[148:151], v[156:159], v[80:83]
    v_mfma_f32_16x16x32_bf16 v[84:87], v[152:155], v[156:159], v[84:87]
    s_waitcnt lgkmcnt(3)
    v_mfma_f32_16x16x32_bf16 v[80:83], v[160:163], v[168:171], v[80:83]
    v_mfma_f32_16x16x32_bf16 v[84:87], v[164:167], v[168:171], v[84:87]
    s_waitcnt lgkmcnt(0)
    v_mfma_f32_16x16x32_bf16 v[80:83], v[172:175], v[180:183], v[80:83]
    v_mfma_f32_16x16x32_bf16 v[84:87], v[176:179], v[180:183], v[84:87]
    s_nop 7
    v_cvt_pk_bf16_f32 v88, v80, v81
    v_cvt_pk_bf16_f32 v89, v82, v83
    v_cvt_pk_bf16_f32 v90, v84, v85
    v_cvt_pk_bf16_f32 v91, v86, v87
    ds_write_b16 v64, v88
    ds_write_b16_d16_hi v65, v88
    ds_write_b16 v66, v89
    ds_write_b16_d16_hi v67, v89
    ds_write_b16 v68, v90
    ds_write_b16_d16_hi v69, v90
    ds_write_b16 v70, v91
    ds_write_b16_d16_hi v71, v91
    v_lshlrev_b32 v72, 4, v0
    v_mov_b32 v76, 0
    v_mov_b32 v77, 0
    v_mov_b32 v78, 0
    v_mov_b32 v79, 0
    s_waitcnt lgkmcnt(0)
    s_barrier
    ds_read_u16 v80, v63 offset:60416
    ds_read_u16 v88, v62 offset:60416
    ds_read_u16 v81, v61 offset:60416
    ds_read_u16 v89, v60 offset:60416
    ds_read_u16 v82, v59 offset:60416
    ds_read_u16 v90, v58 offset:60416
    ds_read_u16 v83, v57 offset:60416
    ds_read_u16 v91, v56 offset:60416
    ds_read_u16 v112, v63 offset:64544
    ds_read_u16 v120, v62 offset:64544
    ds_read_u16 v113, v61 offset:64544
    ds_read_u16 v121, v60 offset:64544
    ds_read_u16 v114, v59 offset:64544
    ds_read_u16 v122, v58 offset:64544
    ds_read_u16 v115, v57 offset:64544
    ds_read_u16 v123, v56 offset:64544
    v_cmp_eq_u32 vcc, 0, v0
    s_and_saveexec_b64 s[74:75], vcc
    ds_write_b128 v72, v[76:79] offset:4096
    ds_write_b128 v72, v[76:79] offset:37376
    s_mov_b64 exec, s[74:75]
    s_waitcnt lgkmcnt(0)
    v_lshl_or_b32 v80, v88, 16, v80
    v_lshl_or_b32 v81, v89, 16, v81
    v_lshl_or_b32 v82, v90, 16, v82
    v_lshl_or_b32 v83, v91, 16, v83
    ds_write_b128 v72, v[80:83] offset:0
    v_lshl_or_b32 v112, v120, 16, v112
    v_lshl_or_b32 v113, v121, 16, v113
    v_lshl_or_b32 v114, v122, 16, v114
    v_lshl_or_b32 v115, v123, 16, v115
    ds_write_b128 v72, v[112:115] offset:33280
    s_waitcnt lgkmcnt(0)
    s_barrier
    ds_read_b128 v[84:87], v72 offset:16
    ds_read_b128 v[116:119], v72 offset:33296
    v_mul_u32_u24 v73, 4160, v0
    v_cmp_gt_u32 vcc, 16, v0
    s_and_saveexec_b64 s[74:75], vcc
    ds_write_b128 v73, v[76:79] offset:4096
    s_mov_b64 exec, s[74:75]
    v_add_u32 v73, 33280, v72
    s_waitcnt lgkmcnt(0)
    v_mov_b32 v88, v81
    v_mov_b32 v89, v82
    v_mov_b32 v90, v83
    v_mov_b32 v91, v84
    v_mov_b32 v92, v85
    v_mov_b32 v93, v86
    v_alignbit_b32 v94, v81, v80, 16
    v_alignbit_b32 v95, v82, v81, 16
    v_alignbit_b32 v96, v83, v82, 16
    v_alignbit_b32 v97, v84, v83, 16
    v_alignbit_b32 v98, v85, v84, 16
    v_alignbit_b32 v99, v86, v85, 16
    v_alignbit_b32 v100, v87, v86, 16
    v_alignbit_b32 v102, v82, v81, 16
    v_alignbit_b32 v103, v83, v82, 16
    v_alignbit_b32 v104, v84, v83, 16
    v_alignbit_b32 v105, v85, v84, 16
    v_alignbit_b32 v106, v86, v85, 16
    v_alignbit_b32 v107, v87, v86, 16
    ds_write_b128 v72, v[94:97] offset:4160
    ds_write_b128 v72, v[88:91] offset:8320
    ds_write_b128 v72, v[102:105] offset:12480
    ds_write_b128 v72, v[82:85] offset:16640
    ds_write_b128 v72, v[96:99] offset:20800
    ds_write_b128 v72, v[90:93] offset:24960
    ds_write_b128 v72, v[104:107] offset:29120

    v_mov_b32 v120, v113
    v_mov_b32 v121, v114
    v_mov_b32 v122, v115
    v_mov_b32 v123, v116
    v_mov_b32 v124, v117
    v_mov_b32 v125, v118
    v_alignbit_b32 v126, v113, v112, 16
    v_alignbit_b32 v127, v114, v113, 16
    v_alignbit_b32 v128, v115, v114, 16
    v_alignbit_b32 v129, v116, v115, 16
    v_alignbit_b32 v130, v117, v116, 16
    v_alignbit_b32 v131, v118, v117, 16
    v_alignbit_b32 v132, v119, v118, 16
    v_alignbit_b32 v134, v114, v113, 16
    v_alignbit_b32 v135, v115, v114, 16
    v_alignbit_b32 v136, v116, v115, 16
    v_alignbit_b32 v137, v117, v116, 16
    v_alignbit_b32 v138, v118, v117, 16
    v_alignbit_b32 v139, v119, v118, 16
    ds_write_b128 v73, v[126:129] offset:4160
    ds_write_b128 v73, v[120:123] offset:8320
    ds_write_b128 v73, v[134:137] offset:12480
    ds_write_b128 v73, v[114:117] offset:16640
    ds_write_b128 v73, v[128:131] offset:20800
    ds_write_b128 v73, v[122:125] offset:24960
    ds_write_b128 v73, v[136:139] offset:29120
    s_lshr_b32 s72, s80, 3
    s_lshl_b32 s72, s72, 5
    s_add_u32 s72, s72, 65536
    v_and_b32 v39, 31, v1
    v_lshl_add_u32 v39, v39, 10, s72
    v_mov_b32 v36, 0
    v_mov_b32 v37, 0
    s_setprio 3
    s_cmp_lg_u32 s70, 0
    s_cbranch_scc1 nop2_17
    s_mov_b32 s69, 0
fl_18:
    v_cmp_ne_u64 vcc, s[100:101], v[36:37]
    s_nop 1
    s_cbranch_vccz fld_19
    s_add_u32 s69, s69, 1
    s_cmp_ge_u32 s69, 262144
    s_cbranch_scc1 fld_19
    s_mov_b64 exec, vcc
    buffer_load_dwordx2 v[36:37], v39, s[16:19], 0 offen sc1
    s_waitcnt vmcnt(0)
    s_branch fl_18
fld_19:
    s_mov_b64 exec, -1
nop2_17:
    s_barrier
    s_mov_b32 s4, s66
    s_mov_b32 s5, s67
    s_mov_b32 s6, 2097152
    s_mov_b32 s7, 0x00020000
    v_lshlrev_b32 v6, 5, v0
    s_lshl_b32 s72, s80, 13
    buffer_load_dwordx4 v[48:51], v6, s[4:7], s72 offen sc1
    buffer_load_dwordx4 v[52:55], v6, s[4:7], s72 offen offset:16 sc1
    s_setprio 1
    v_lshrrev_b32 v74, 7, v0
    v_mul_u32_u24 v74, 4576, v74
    v_and_b32 v75, 127, v0
    v_lshl_add_u32 v74, v75, 5, v74
    v_add_u32 v74, 69152, v74
    s_waitcnt vmcnt(0)
    ds_write_b128 v74, v[48:51]
    ds_write_b128 v74, v[52:55] offset:16
    s_add_u32 s4, s66, 2097152
    s_addc_u32 s5, s67, 0
    s_mov_b32 s6, 2097152
    s_mov_b32 s7, 0x00020000
    s_lshr_b32 s72, s70, 1
    s_and_b32 s73, s70, 1
    s_lshl_b32 s73, s73, 8
    s_mul_i32 s74, s72, 33280
    s_sub_u32 s74, s74, s73
    s_add_u32 s74, s74, 29392
    v_and_b32 v2, 7, v1
    v_mul_u32_u24 v2, 4160, v2
    v_sub_u32 v2, s74, v2
    v_lshrrev_b32 v3, 4, v1
    v_bfe_u32 v4, v1, 3, 1
    v_sub_u32 v4, v3, v4
    v_lshl_add_u32 v2, v4, 4, v2
    s_mul_i32 s74, s72, 4576
    s_sub_u32 s75, s74, s73
    s_add_u32 s75, s75, 68928
    v_and_b32 v4, 15, v1
    v_lshlrev_b32 v5, 5, v4
    v_lshl_add_u32 v5, v3, 4, v5
    v_add_u32 v5, s75, v5
    s_waitcnt lgkmcnt(0)
    s_barrier
    ds_read_b128 v[144:147], v5 offset:192
    ds_read_b128 v[108:111], v2 offset:192
    ds_read_b128 v[148:151], v5 offset:704
    ds_read_b128 v[104:107], v2 offset:704
    ds_read_b128 v[152:155], v5 offset:1216
    ds_read_b128 v[100:103], v2 offset:1216
    ds_read_b128 v[156:159], v5 offset:1728
    ds_read_b128 v[96:99], v2 offset:1728
    ds_read_b128 v[160:163], v5 offset:2240
    ds_read_b128 v[92:95], v2 offset:2240
    ds_read_b128 v[164:167], v5 offset:2752
    ds_read_b128 v[88:91], v2 offset:2752
    ds_read_b128 v[168:171], v5 offset:3264
    ds_read_b128 v[84:87], v2 offset:3264
    ds_read_b128 v[172:175], v5 offset:3776
    ds_read_b128 v[80:83], v2 offset:3776
    s_waitcnt lgkmcnt(14)
    v_mfma_f32_16x16x32_bf16 v[76:79], v[108:111], v[144:147], 0
    s_waitcnt lgkmcnt(12)
    v_mfma_f32_16x16x32_bf16 v[72:75], v[104:107], v[144:147], 0
    v_mfma_f32_16x16x32_bf16 v[76:79], v[104:107], v[148:151], v[76:79]
    s_waitcnt lgkmcnt(10)
    v_mfma_f32_16x16x32_bf16 v[68:71], v[100:103], v[144:147], 0
    v_mfma_f32_16x16x32_bf16 v[72:75], v[100:103], v[148:151], v[72:75]
    v_mfma_f32_16x16x32_bf16 v[76:79], v[100:103], v[152:155], v[76:79]
    s_waitcnt lgkmcnt(8)
    v_mfma_f32_16x16x32_bf16 v[64:67], v[96:99], v[144:147], 0
    v_mfma_f32_16x16x32_bf16 v[68:71], v[96:99], v[148:151], v[68:71]
    v_mfma_f32_16x16x32_bf16 v[72:75], v[96:99], v[152:155], v[72:75]
    v_mfma_f32_16x16x32_bf16 v[76:79], v[96:99], v[156:159], v[76:79]
    s_waitcnt lgkmcnt(6)
    v_mfma_f32_16x16x32_bf16 v[60:63], v[92:95], v[144:147], 0
    v_mfma_f32_16x16x32_bf16 v[64:67], v[92:95], v[148:151], v[64:67]
    v_mfma_f32_16x16x32_bf16 v[68:71], v[92:95], v[152:155], v[68:71]
    v_mfma_f32_16x16x32_bf16 v[72:75], v[92:95], v[156:159], v[72:75]
    v_mfma_f32_16x16x32_bf16 v[76:79], v[92:95], v[160:163], v[76:79]
    s_waitcnt lgkmcnt(4)
    v_mfma_f32_16x16x32_bf16 v[56:59], v[88:91], v[144:147], 0
    v_mfma_f32_16x16x32_bf16 v[60:63], v[88:91], v[148:151], v[60:63]
    v_mfma_f32_16x16x32_bf16 v[64:67], v[88:91], v[152:155], v[64:67]
    v_mfma_f32_16x16x32_bf16 v[68:71], v[88:91], v[156:159], v[68:71]
    v_mfma_f32_16x16x32_bf16 v[72:75], v[88:91], v[160:163], v[72:75]
    v_mfma_f32_16x16x32_bf16 v[76:79], v[88:91], v[164:167], v[76:79]
    s_waitcnt lgkmcnt(2)
    v_mfma_f32_16x16x32_bf16 v[52:55], v[84:87], v[144:147], 0
    v_mfma_f32_16x16x32_bf16 v[56:59], v[84:87], v[148:151], v[56:59]
    v_mfma_f32_16x16x32_bf16 v[60:63], v[84:87], v[152:155], v[60:63]
    v_mfma_f32_16x16x32_bf16 v[64:67], v[84:87], v[156:159], v[64:67]
    v_mfma_f32_16x16x32_bf16 v[68:71], v[84:87], v[160:163], v[68:71]
    v_mfma_f32_16x16x32_bf16 v[72:75], v[84:87], v[164:167], v[72:75]
    v_mfma_f32_16x16x32_bf16 v[76:79], v[84:87], v[168:171], v[76:79]
    s_waitcnt lgkmcnt(0)
    ds_read_b128 v[176:179], v5 offset:128
    ds_read_b128 v[140:143], v2 offset:128
    ds_read_b128 v[180:183], v5 offset:640
    ds_read_b128 v[136:139], v2 offset:640
    ds_read_b128 v[184:187], v5 offset:1152
    ds_read_b128 v[132:135], v2 offset:1152
    ds_read_b128 v[188:191], v5 offset:1664
    ds_read_b128 v[128:131], v2 offset:1664
    ds_read_b128 v[192:195], v5 offset:2176
    ds_read_b128 v[124:127], v2 offset:2176
    ds_read_b128 v[196:199], v5 offset:2688
    ds_read_b128 v[120:123], v2 offset:2688
    ds_read_b128 v[200:203], v5 offset:3200
    ds_read_b128 v[116:119], v2 offset:3200
    ds_read_b128 v[204:207], v5 offset:3712
    ds_read_b128 v[112:115], v2 offset:3712
    v_mfma_f32_16x16x32_bf16 v[48:51], v[80:83], v[144:147], 0
    v_mfma_f32_16x16x32_bf16 v[52:55], v[80:83], v[148:151], v[52:55]
    v_mfma_f32_16x16x32_bf16 v[56:59], v[80:83], v[152:155], v[56:59]
    v_mfma_f32_16x16x32_bf16 v[60:63], v[80:83], v[156:159], v[60:63]
    v_mfma_f32_16x16x32_bf16 v[64:67], v[80:83], v[160:163], v[64:67]
    v_mfma_f32_16x16x32_bf16 v[68:71], v[80:83], v[164:167], v[68:71]
    v_mfma_f32_16x16x32_bf16 v[72:75], v[80:83], v[168:171], v[72:75]
    v_mfma_f32_16x16x32_bf16 v[76:79], v[80:83], v[172:175], v[76:79]
    s_waitcnt lgkmcnt(0)
    v_mfma_f32_16x16x32_bf16 v[76:79], v[140:143], v[176:179], v[76:79]
    ds_read_b128 v[144:147], v5 offset:64
    v_mfma_f32_16x16x32_bf16 v[72:75], v[136:139], v[176:179], v[72:75]
    ds_read_b128 v[108:111], v2 offset:64
    v_mfma_f32_16x16x32_bf16 v[76:79], v[136:139], v[180:183], v[76:79]
    ds_read_b128 v[148:151], v5 offset:576
    v_mfma_f32_16x16x32_bf16 v[68:71], v[132:135], v[176:179], v[68:71]
    ds_read_b128 v[104:107], v2 offset:576
    v_mfma_f32_16x16x32_bf16 v[72:75], v[132:135], v[180:183], v[72:75]
    ds_read_b128 v[152:155], v5 offset:1088
    v_mfma_f32_16x16x32_bf16 v[76:79], v[132:135], v[184:187], v[76:79]
    ds_read_b128 v[100:103], v2 offset:1088
    v_mfma_f32_16x16x32_bf16 v[64:67], v[128:131], v[176:179], v[64:67]
    ds_read_b128 v[156:159], v5 offset:1600
    v_mfma_f32_16x16x32_bf16 v[68:71], v[128:131], v[180:183], v[68:71]
    ds_read_b128 v[96:99], v2 offset:1600
    v_mfma_f32_16x16x32_bf16 v[72:75], v[128:131], v[184:187], v[72:75]
    ds_read_b128 v[160:163], v5 offset:2112
    v_mfma_f32_16x16x32_bf16 v[76:79], v[128:131], v[188:191], v[76:79]
    ds_read_b128 v[92:95], v2 offset:2112
    v_mfma_f32_16x16x32_bf16 v[60:63], v[124:127], v[176:179], v[60:63]
    ds_read_b128 v[164:167], v5 offset:2624
    v_mfma_f32_16x16x32_bf16 v[64:67], v[124:127], v[180:183], v[64:67]
    ds_read_b128 v[88:91], v2 offset:2624
    v_mfma_f32_16x16x32_bf16 v[68:71], v[124:127], v[184:187], v[68:71]
    ds_read_b128 v[168:171], v5 offset:3136
    v_mfma_f32_16x16x32_bf16 v[72:75], v[124:127], v[188:191], v[72:75]
    ds_read_b128 v[84:87], v2 offset:3136
    v_mfma_f32_16x16x32_bf16 v[76:79], v[124:127], v[192:195], v[76:79]
    ds_read_b128 v[172:175], v5 offset:3648
    v_mfma_f32_16x16x32_bf16 v[56:59], v[120:123], v[176:179], v[56:59]
    ds_read_b128 v[80:83], v2 offset:3648
    v_mfma_f32_16x16x32_bf16 v[60:63], v[120:123], v[180:183], v[60:63]
    v_mfma_f32_16x16x32_bf16 v[64:67], v[120:123], v[184:187], v[64:67]
    v_mfma_f32_16x16x32_bf16 v[68:71], v[120:123], v[188:191], v[68:71]
    v_mfma_f32_16x16x32_bf16 v[72:75], v[120:123], v[192:195], v[72:75]
    v_mfma_f32_16x16x32_bf16 v[76:79], v[120:123], v[196:199], v[76:79]
    v_mfma_f32_16x16x32_bf16 v[52:55], v[116:119], v[176:179], v[52:55]
    v_mfma_f32_16x16x32_bf16 v[56:59], v[116:119], v[180:183], v[56:59]
    v_mfma_f32_16x16x32_bf16 v[60:63], v[116:119], v[184:187], v[60:63]
    v_mfma_f32_16x16x32_bf16 v[64:67], v[116:119], v[188:191], v[64:67]
    v_mfma_f32_16x16x32_bf16 v[68:71], v[116:119], v[192:195], v[68:71]
    v_mfma_f32_16x16x32_bf16 v[72:75], v[116:119], v[196:199], v[72:75]
    v_mfma_f32_16x16x32_bf16 v[76:79], v[116:119], v[200:203], v[76:79]
    v_mfma_f32_16x16x32_bf16 v[48:51], v[112:115], v[176:179], v[48:51]
    v_mfma_f32_16x16x32_bf16 v[52:55], v[112:115], v[180:183], v[52:55]
    v_mfma_f32_16x16x32_bf16 v[56:59], v[112:115], v[184:187], v[56:59]
    v_mfma_f32_16x16x32_bf16 v[60:63], v[112:115], v[188:191], v[60:63]
    v_mfma_f32_16x16x32_bf16 v[64:67], v[112:115], v[192:195], v[64:67]
    v_mfma_f32_16x16x32_bf16 v[68:71], v[112:115], v[196:199], v[68:71]
    v_mfma_f32_16x16x32_bf16 v[72:75], v[112:115], v[200:203], v[72:75]
    v_mfma_f32_16x16x32_bf16 v[76:79], v[112:115], v[204:207], v[76:79]
    s_waitcnt lgkmcnt(0)
    v_mfma_f32_16x16x32_bf16 v[76:79], v[108:111], v[144:147], v[76:79]
    ds_read_b128 v[176:179], v5 offset:0
    v_mfma_f32_16x16x32_bf16 v[72:75], v[104:107], v[144:147], v[72:75]
    ds_read_b128 v[140:143], v2 offset:0
    v_mfma_f32_16x16x32_bf16 v[76:79], v[104:107], v[148:151], v[76:79]
    ds_read_b128 v[180:183], v5 offset:512
    v_mfma_f32_16x16x32_bf16 v[68:71], v[100:103], v[144:147], v[68:71]
    ds_read_b128 v[136:139], v2 offset:512
    v_mfma_f32_16x16x32_bf16 v[72:75], v[100:103], v[148:151], v[72:75]
    ds_read_b128 v[184:187], v5 offset:1024
    v_mfma_f32_16x16x32_bf16 v[76:79], v[100:103], v[152:155], v[76:79]
    ds_read_b128 v[132:135], v2 offset:1024
    v_mfma_f32_16x16x32_bf16 v[64:67], v[96:99], v[144:147], v[64:67]
    ds_read_b128 v[188:191], v5 offset:1536
    v_mfma_f32_16x16x32_bf16 v[68:71], v[96:99], v[148:151], v[68:71]
    ds_read_b128 v[128:131], v2 offset:1536
    v_mfma_f32_16x16x32_bf16 v[72:75], v[96:99], v[152:155], v[72:75]
    ds_read_b128 v[192:195], v5 offset:2048
    v_mfma_f32_16x16x32_bf16 v[76:79], v[96:99], v[156:159], v[76:79]
    ds_read_b128 v[124:127], v2 offset:2048
    v_mfma_f32_16x16x32_bf16 v[60:63], v[92:95], v[144:147], v[60:63]
    ds_read_b128 v[196:199], v5 offset:2560
    v_mfma_f32_16x16x32_bf16 v[64:67], v[92:95], v[148:151], v[64:67]
    ds_read_b128 v[120:123], v2 offset:2560
    v_mfma_f32_16x16x32_bf16 v[68:71], v[92:95], v[152:155], v[68:71]
    ds_read_b128 v[200:203], v5 offset:3072
    v_mfma_f32_16x16x32_bf16 v[72:75], v[92:95], v[156:159], v[72:75]
    ds_read_b128 v[116:119], v2 offset:3072
    v_mfma_f32_16x16x32_bf16 v[76:79], v[92:95], v[160:163], v[76:79]
    ds_read_b128 v[204:207], v5 offset:3584
    v_mfma_f32_16x16x32_bf16 v[56:59], v[88:91], v[144:147], v[56:59]
    ds_read_b128 v[112:115], v2 offset:3584
    v_mfma_f32_16x16x32_bf16 v[60:63], v[88:91], v[148:151], v[60:63]
    v_mfma_f32_16x16x32_bf16 v[64:67], v[88:91], v[152:155], v[64:67]
    v_mfma_f32_16x16x32_bf16 v[68:71], v[88:91], v[156:159], v[68:71]
    v_mfma_f32_16x16x32_bf16 v[72:75], v[88:91], v[160:163], v[72:75]
    v_mfma_f32_16x16x32_bf16 v[76:79], v[88:91], v[164:167], v[76:79]
    v_mfma_f32_16x16x32_bf16 v[52:55], v[84:87], v[144:147], v[52:55]
    v_mfma_f32_16x16x32_bf16 v[56:59], v[84:87], v[148:151], v[56:59]
    v_mfma_f32_16x16x32_bf16 v[60:63], v[84:87], v[152:155], v[60:63]
    v_mfma_f32_16x16x32_bf16 v[64:67], v[84:87], v[156:159], v[64:67]
    v_mfma_f32_16x16x32_bf16 v[68:71], v[84:87], v[160:163], v[68:71]
    v_mfma_f32_16x16x32_bf16 v[72:75], v[84:87], v[164:167], v[72:75]
    v_mfma_f32_16x16x32_bf16 v[76:79], v[84:87], v[168:171], v[76:79]
    v_mfma_f32_16x16x32_bf16 v[48:51], v[80:83], v[144:147], v[48:51]
    v_mfma_f32_16x16x32_bf16 v[52:55], v[80:83], v[148:151], v[52:55]
    v_mfma_f32_16x16x32_bf16 v[56:59], v[80:83], v[152:155], v[56:59]
    v_mfma_f32_16x16x32_bf16 v[60:63], v[80:83], v[156:159], v[60:63]
    v_mfma_f32_16x16x32_bf16 v[64:67], v[80:83], v[160:163], v[64:67]
    v_mfma_f32_16x16x32_bf16 v[68:71], v[80:83], v[164:167], v[68:71]
    v_mfma_f32_16x16x32_bf16 v[72:75], v[80:83], v[168:171], v[72:75]
    v_mfma_f32_16x16x32_bf16 v[76:79], v[80:83], v[172:175], v[76:79]
    s_waitcnt lgkmcnt(0)
    v_mfma_f32_16x16x32_bf16 v[76:79], v[140:143], v[176:179], v[76:79]
    v_mfma_f32_16x16x32_bf16 v[72:75], v[136:139], v[176:179], v[72:75]
    v_mfma_f32_16x16x32_bf16 v[76:79], v[136:139], v[180:183], v[76:79]
    v_mfma_f32_16x16x32_bf16 v[68:71], v[132:135], v[176:179], v[68:71]
    v_mfma_f32_16x16x32_bf16 v[72:75], v[132:135], v[180:183], v[72:75]
    v_mfma_f32_16x16x32_bf16 v[76:79], v[132:135], v[184:187], v[76:79]
    v_mfma_f32_16x16x32_bf16 v[64:67], v[128:131], v[176:179], v[64:67]
    v_mfma_f32_16x16x32_bf16 v[68:71], v[128:131], v[180:183], v[68:71]
    v_mfma_f32_16x16x32_bf16 v[72:75], v[128:131], v[184:187], v[72:75]
    v_mfma_f32_16x16x32_bf16 v[76:79], v[128:131], v[188:191], v[76:79]
    v_mfma_f32_16x16x32_bf16 v[60:63], v[124:127], v[176:179], v[60:63]
    v_mfma_f32_16x16x32_bf16 v[64:67], v[124:127], v[180:183], v[64:67]
    v_mfma_f32_16x16x32_bf16 v[68:71], v[124:127], v[184:187], v[68:71]
    v_mfma_f32_16x16x32_bf16 v[72:75], v[124:127], v[188:191], v[72:75]
    v_mfma_f32_16x16x32_bf16 v[76:79], v[124:127], v[192:195], v[76:79]
    v_mfma_f32_16x16x32_bf16 v[56:59], v[120:123], v[176:179], v[56:59]
    v_mfma_f32_16x16x32_bf16 v[60:63], v[120:123], v[180:183], v[60:63]
    v_mfma_f32_16x16x32_bf16 v[64:67], v[120:123], v[184:187], v[64:67]
    v_mfma_f32_16x16x32_bf16 v[68:71], v[120:123], v[188:191], v[68:71]
    v_mfma_f32_16x16x32_bf16 v[72:75], v[120:123], v[192:195], v[72:75]
    v_mfma_f32_16x16x32_bf16 v[76:79], v[120:123], v[196:199], v[76:79]
    v_mfma_f32_16x16x32_bf16 v[52:55], v[116:119], v[176:179], v[52:55]
    v_mfma_f32_16x16x32_bf16 v[56:59], v[116:119], v[180:183], v[56:59]
    v_mfma_f32_16x16x32_bf16 v[60:63], v[116:119], v[184:187], v[60:63]
    v_mfma_f32_16x16x32_bf16 v[64:67], v[116:119], v[188:191], v[64:67]
    v_mfma_f32_16x16x32_bf16 v[68:71], v[116:119], v[192:195], v[68:71]
    v_mfma_f32_16x16x32_bf16 v[72:75], v[116:119], v[196:199], v[72:75]
    v_mfma_f32_16x16x32_bf16 v[76:79], v[116:119], v[200:203], v[76:79]
    v_mfma_f32_16x16x32_bf16 v[48:51], v[112:115], v[176:179], v[48:51]
    v_mfma_f32_16x16x32_bf16 v[52:55], v[112:115], v[180:183], v[52:55]
    v_mfma_f32_16x16x32_bf16 v[56:59], v[112:115], v[184:187], v[56:59]
    v_mfma_f32_16x16x32_bf16 v[60:63], v[112:115], v[188:191], v[60:63]
    v_mfma_f32_16x16x32_bf16 v[64:67], v[112:115], v[192:195], v[64:67]
    v_mfma_f32_16x16x32_bf16 v[68:71], v[112:115], v[196:199], v[68:71]
    v_mfma_f32_16x16x32_bf16 v[72:75], v[112:115], v[200:203], v[72:75]
    v_mfma_f32_16x16x32_bf16 v[76:79], v[112:115], v[204:207], v[76:79]
    s_barrier
    s_lshl_b32 s76, s70, 12
    v_lshl_add_u32 v6, v1, 4, s76
    s_xor_b32 s76, s76, 4096
    v_lshl_add_u32 v7, v1, 4, s76
    s_nop 7
    s_cmp_eq_u32 s73, 0
    s_cbranch_scc1 cv_20
    v_swap_b32 v48, v64
    v_swap_b32 v49, v65
    v_swap_b32 v50, v66
    v_swap_b32 v51, v67
    v_swap_b32 v52, v68
    v_swap_b32 v53, v69
    v_swap_b32 v54, v70
    v_swap_b32 v55, v71
    v_swap_b32 v56, v72
    v_swap_b32 v57, v73
    v_swap_b32 v58, v74
    v_swap_b32 v59, v75
    v_swap_b32 v60, v76
    v_swap_b32 v61, v77
    v_swap_b32 v62, v78
    v_swap_b32 v63, v79
cv_20:
    s_nop 1
    ds_write_b128 v6, v[64:67] offset:0
    ds_write_b128 v6, v[68:71] offset:1024
    ds_write_b128 v6, v[72:75] offset:2048
    ds_write_b128 v6, v[76:79] offset:3072
    s_lshl_b32 s77, s73, 3
    s_add_u32 s75, s74, s77
    s_add_u32 s75, s75, 69152
    v_lshlrev_b32 v8, 5, v4
    v_lshl_add_u32 v8, v3, 3, v8
    v_add_u32 v9, s75, v8
    ds_read_b64 v[80:81], v9 offset:0
    ds_read_b64 v[82:83], v9 offset:512
    ds_read_b64 v[84:85], v9 offset:1024
    ds_read_b64 v[86:87], v9 offset:1536
    s_waitcnt lgkmcnt(0)
    s_barrier
    ds_read_b128 v[64:67], v7 offset:0
    ds_read_b128 v[68:71], v7 offset:1024
    ds_read_b128 v[72:75], v7 offset:2048
    ds_read_b128 v[76:79], v7 offset:3072
    v_mov_b32 v44, v45
    v_lshlrev_b32 v88, 16, v80
    v_and_b32 v89, 0xffff0000, v80
    v_lshlrev_b32 v90, 16, v81
    v_and_b32 v91, 0xffff0000, v81
    v_lshlrev_b32 v92, 16, v82
    v_and_b32 v93, 0xffff0000, v82
    v_lshlrev_b32 v94, 16, v83
    v_and_b32 v95, 0xffff0000, v83
    v_lshlrev_b32 v96, 16, v84
    v_and_b32 v97, 0xffff0000, v84
    v_lshlrev_b32 v98, 16, v85
    v_and_b32 v99, 0xffff0000, v85
    v_lshlrev_b32 v100, 16, v86
    v_and_b32 v101, 0xffff0000, v86
    v_lshlrev_b32 v102, 16, v87
    v_and_b32 v103, 0xffff0000, v87
    v_pk_mul_f32 v[88:89], v[88:89], v[44:45]
    v_pk_mul_f32 v[90:91], v[90:91], v[44:45]
    v_pk_mul_f32 v[92:93], v[92:93], v[44:45]
    v_pk_mul_f32 v[94:95], v[94:95], v[44:45]
    v_pk_mul_f32 v[96:97], v[96:97], v[44:45]
    v_pk_mul_f32 v[98:99], v[98:99], v[44:45]
    v_pk_mul_f32 v[100:101], v[100:101], v[44:45]
    v_pk_mul_f32 v[102:103], v[102:103], v[44:45]
    v_cvt_pk_bf16_f32 v80, v88, v89
    v_cvt_pk_bf16_f32 v81, v90, v91
    v_cvt_pk_bf16_f32 v82, v92, v93
    v_cvt_pk_bf16_f32 v83, v94, v95
    v_cvt_pk_bf16_f32 v84, v96, v97
    v_cvt_pk_bf16_f32 v85, v98, v99
    v_cvt_pk_bf16_f32 v86, v100, v101
    v_cvt_pk_bf16_f32 v87, v102, v103
    v_lshlrev_b32 v88, 16, v80
    v_and_b32 v89, 0xffff0000, v80
    v_lshlrev_b32 v90, 16, v81
    v_and_b32 v91, 0xffff0000, v81
    v_lshlrev_b32 v92, 16, v82
    v_and_b32 v93, 0xffff0000, v82
    v_lshlrev_b32 v94, 16, v83
    v_and_b32 v95, 0xffff0000, v83
    v_lshlrev_b32 v96, 16, v84
    v_and_b32 v97, 0xffff0000, v84
    v_lshlrev_b32 v98, 16, v85
    v_and_b32 v99, 0xffff0000, v85
    v_lshlrev_b32 v100, 16, v86
    v_and_b32 v101, 0xffff0000, v86
    v_lshlrev_b32 v102, 16, v87
    v_and_b32 v103, 0xffff0000, v87
    s_waitcnt lgkmcnt(0)
    v_pk_add_f32 v[48:49], v[48:49], v[64:65]
    v_pk_add_f32 v[50:51], v[50:51], v[66:67]
    v_pk_add_f32 v[52:53], v[52:53], v[68:69]
    v_pk_add_f32 v[54:55], v[54:55], v[70:71]
    v_pk_add_f32 v[56:57], v[56:57], v[72:73]
    v_pk_add_f32 v[58:59], v[58:59], v[74:75]
    v_pk_add_f32 v[60:61], v[60:61], v[76:77]
    v_pk_add_f32 v[62:63], v[62:63], v[78:79]
    v_cvt_pk_bf16_f32 v80, v48, v49
    v_cvt_pk_bf16_f32 v81, v50, v51
    v_cvt_pk_bf16_f32 v82, v52, v53
    v_cvt_pk_bf16_f32 v83, v54, v55
    v_cvt_pk_bf16_f32 v84, v56, v57
    v_cvt_pk_bf16_f32 v85, v58, v59
    v_cvt_pk_bf16_f32 v86, v60, v61
    v_cvt_pk_bf16_f32 v87, v62, v63
    v_lshlrev_b32 v48, 16, v80
    v_and_b32 v49, 0xffff0000, v80
    v_lshlrev_b32 v50, 16, v81
    v_and_b32 v51, 0xffff0000, v81
    v_lshlrev_b32 v52, 16, v82
    v_and_b32 v53, 0xffff0000, v82
    v_lshlrev_b32 v54, 16, v83
    v_and_b32 v55, 0xffff0000, v83
    v_lshlrev_b32 v56, 16, v84
    v_and_b32 v57, 0xffff0000, v84
    v_lshlrev_b32 v58, 16, v85
    v_and_b32 v59, 0xffff0000, v85
    v_lshlrev_b32 v60, 16, v86
    v_and_b32 v61, 0xffff0000, v86
    v_lshlrev_b32 v62, 16, v87
    v_and_b32 v63, 0xffff0000, v87
    v_pk_add_f32 v[48:49], v[48:49], v[88:89]
    v_pk_add_f32 v[50:51], v[50:51], v[90:91]
    v_pk_add_f32 v[52:53], v[52:53], v[92:93]
    v_pk_add_f32 v[54:55], v[54:55], v[94:95]
    v_pk_add_f32 v[56:57], v[56:57], v[96:97]
    v_pk_add_f32 v[58:59], v[58:59], v[98:99]
    v_pk_add_f32 v[60:61], v[60:61], v[100:101]
    v_pk_add_f32 v[62:63], v[62:63], v[102:103]
    v_cvt_pk_bf16_f32 v80, v48, v49
    v_cvt_pk_bf16_f32 v81, v50, v51
    v_cvt_pk_bf16_f32 v82, v52, v53
    v_cvt_pk_bf16_f32 v83, v54, v55
    v_cvt_pk_bf16_f32 v84, v56, v57
    v_cvt_pk_bf16_f32 v85, v58, v59
    v_cvt_pk_bf16_f32 v86, v60, v61
    v_cvt_pk_bf16_f32 v87, v62, v63
    s_lshl_b32 s75, s80, 13
    s_lshl_b32 s76, s72, 12
    s_add_u32 s75, s75, s76
    s_add_u32 s75, s75, s77
    buffer_store_dwordx2 v[80:81], v8, s[4:7], s75 offen offset:0 sc1
    buffer_store_dwordx2 v[82:83], v8, s[4:7], s75 offen offset:512 sc1
    buffer_store_dwordx2 v[84:85], v8, s[4:7], s75 offen offset:1024 sc1
    buffer_store_dwordx2 v[86:87], v8, s[4:7], s75 offen offset:1536 sc1
    s_lshl_b32 s72, s80, 7
    s_add_u32 s72, s72, 32768
    s_waitcnt vmcnt(0)
    s_barrier
    s_cmp_lg_u32 s70, 0
    s_cbranch_scc1 sg_22
    v_mov_b32 v74, s100
    v_mov_b32 v75, s101
    v_mov_b32 v76, 0
    s_mov_b64 exec, 1
    buffer_store_dwordx2 v[74:75], v76, s[16:19], s72 offen sc1
    s_mov_b64 exec, -1
sg_22:
k_end:
    s_endpgm
.section .rodata,"a"
.p2align 6
.amdhsa_kernel gated_mix__ssm_conv_s4d__dense_activation_squared_relu__prompt_kernel
  .amdhsa_next_free_vgpr 256
  .amdhsa_next_free_sgpr 102
  .amdhsa_accum_offset 256
  .amdhsa_group_segment_fixed_size 0
  .amdhsa_kernarg_size 128
  .amdhsa_user_sgpr_count 2
  .amdhsa_user_sgpr_kernarg_segment_ptr 1
  .amdhsa_system_sgpr_workgroup_id_x 1
  .amdhsa_float_denorm_mode_32 3
.end_amdhsa_kernel
```
